```python
import torch

def _softmax(x, axis=-1):
    return torch.softmax(x, dim=axis)
def _gelu(x):
    return torch.nn.functional.gelu(x, approximate="tanh")
def _silu(x):
    return torch.nn.functional.silu(x)
def _sigmoid(x):
    return torch.sigmoid(x)
def _layernorm(x, axis=-1, eps=1e-5):
    m = x.mean(dim=axis, keepdim=True)
    v = x.var(dim=axis, keepdim=True, unbiased=False)
    return (x - m) / torch.sqrt(v + eps)
def _scatter_add(tgt, idx, src, axis=0):
    return tgt.clone().index_add_(axis, idx, src)
def _segment_sum(src, seg, n):
    out = torch.zeros((n,) + src.shape[1:], dtype=src.dtype)
    return out.index_add_(0, seg, src)
def _pad(x, pw):
    flat = tuple(v for pair in reversed(pw) for v in pair)
    return torch.nn.functional.pad(x, flat)

kernel_name = 'standalone__edm_precond__diffusion'

def setup_inputs():

    _w = (lambda a: (lambda t: t.to(torch.bfloat16) if t.is_floating_point() else t)(torch.as_tensor(a)))
    B, C, HW = 2, 512, 64
    return {
        "x": _w((lambda *s: torch.randn(*s, dtype=torch.bfloat16) * 0.4)(B, C, HW, HW)),
        "sigma": _w((lambda _x: torch.exp(torch.as_tensor(_x)))((lambda *s: torch.randn(*s, dtype=torch.bfloat16) * 3.2)(B))),
        "w_in": _w((lambda *s: torch.randn(*s, dtype=torch.bfloat16) * 3.2)(C, C) * (C ** -0.5)),
        "w_emb": _w((lambda *s: torch.randn(*s, dtype=torch.bfloat16) * 3.2)(1, C)),
        "w_out": _w((lambda *s: torch.randn(*s, dtype=torch.bfloat16) * 3.2)(C, C) * (C ** -0.5)),
    }

def reference(x, sigma, w_in, w_emb, w_out):
    B, C, H, W = x.shape
    sigma_data = 0.5
    s = sigma.reshape(B, 1, 1, 1)
    denom = s * s + sigma_data * sigma_data
    c_skip = (sigma_data * sigma_data) / denom
    c_out  = s * sigma_data / torch.sqrt(denom)
    c_in   = 1.0 / torch.sqrt(denom)
    c_noise = 0.25 * torch.log(sigma).reshape(B, 1)
    h = torch.einsum("bchw,cd->bdhw", c_in * x, w_in)
    h = h + (c_noise @ w_emb).reshape(B, C, 1, 1)
    h = _silu(h)
    Fx = torch.einsum("bchw,cd->bdhw", h, w_out)
    return c_skip * x + c_out * Fx
```

```asm
; @launch grid=(256,1,1) block=(512,1,1) lds=163840
.amdgcn_target "amdgcn-amd-amdhsa--gfx950"
.text
.globl standalone__edm_precond__diffusion_kernel
.p2align 8
.type standalone__edm_precond__diffusion_kernel,@function
standalone__edm_precond__diffusion_kernel:
    s_load_dwordx16 s[36:51], s[0:1], 0
    s_cmp_ge_u32 s2, 256
    s_cbranch_scc1 Lend
    v_lshrrev_b32 v2, 6, v0
    v_and_b32 v1, 63, v0
    v_readfirstlane_b32 s28, v2
    s_bfe_u32 s30, s2, 0x20003
    s_lshr_b32 s5, s2, 5
    s_and_b32 s3, s2, 7
    s_lshl_b32 s6, s5, 3
    s_add_u32 s3, s3, s6
    s_lshr_b32 s29, s3, 5
    s_and_b32 s3, s3, 31
    s_lshl_b32 s3, s3, 8
    s_lshl_b32 s6, s29, 22
    s_add_u32 s31, s3, s6
    s_cmp_lt_u32 s28, 4
    s_cbranch_scc0 Lload
    s_getpc_b64 s[74:75]
Lpc:
    s_lshr_b32 s3, s2, 3
    s_lshl_b32 s3, s3, 2
    s_add_u32 s3, s3, s28
    s_mul_i32 s3, s3, 192
    s_min_u32 s3, s3, Lend-Lpc-128
    s_add_u32 s74, s74, s3
    s_addc_u32 s75, s75, 0
    s_load_dword s73, s[74:75], 0
    s_load_dword s73, s[74:75], 64
    s_load_dword s73, s[74:75], 128
    s_branch Lcons
Lload:
    s_and_b32 s54, s28, 1
    s_lshl_b32 s4, s30, 8
    s_cmp_lt_u32 s28, 6
    s_cselect_b32 s53, 13, 10
    s_cselect_b32 s52, s31, s4
    s_lshl_b32 s3, s54, 7
    s_add_u32 s52, s52, s3
    s_sub_u32 s4, s28, 4
    s_mul_i32 s32, s4, 40960
    s_add_u32 s3, s30, s5
    s_and_b32 s3, s3, 3
    s_lshl_b32 s3, s3, 7
    s_lshl_b32 s33, s3, s53
    s_lshl_b32 s55, s30, 17
    v_lshrrev_b32 v2, 3, v1
    v_and_b32 v3, 6, v2
    v_and_b32 v12, 7, v1
    v_xor_b32 v3, v3, v12
    v_lshlrev_b32 v2, s53, v2
    v_lshl_add_u32 v3, v3, 4, v2
    v_add_u32 v4, s52, v3
    s_lshl_b32 s3, 8, s53
    s_sub_u32 s3, s3, 1024
    s_lshl_b32 s34, 48, s53
    v_add_u32 v5, s3, v4
    v_add_u32 v6, s34, v5
    v_add_u32 v6, s3, v6
    v_add_u32 v7, s3, v6
    s_lshl_b32 s34, 80, s53
    s_lshl_b32 s5, 16, s53
    s_lshl_b32 s35, 0x200, s53
    s_sub_u32 s35, s35, 1
    v_and_b32 v8, 31, v1
    v_lshlrev_b32 v8, 7, v8
    s_lshr_b32 s7, s2, 3
    s_lshl_b32 s7, s7, 2
    s_add_u32 s7, s7, s28
    s_sub_u32 s7, s7, 4
    s_lshl_b32 s7, s7, 12
    s_mov_b32 s15, 0x20000
    s_mov_b32 s18, 0x80000
    s_mov_b32 s19, 0x20000
    s_mov_b32 s66, 0x10000
    s_mov_b32 s67, 0x20000
    v_lshrrev_b32 v2, 2, v1
    v_add_u32 v2, s30, v2
    v_and_b32 v2, 3, v2
    v_lshlrev_b32 v2, 11, v2
    v_and_b32 v3, 3, v1
    v_cmp_eq_u32 vcc, 3, v3
    v_lshlrev_b32 v3, 2, v3
    s_andn2_b32 s3, s2, 24
    s_lshl_b32 s3, s3, 8
    s_lshl_b32 s4, s54, 4
    s_add_u32 s3, s3, s4
    v_mov_b32 v11, 128
    v_cndmask_b32 v3, v3, v11, vcc
    v_add3_u32 v16, v2, v3, s3
    v_lshlrev_b32 v10, 2, v1
    s_mov_b32 s22, 1024
    s_mov_b32 s23, 0x20000
    s_lshl_b32 s3, s30, 20
    s_add_u32 s3, s3, s31
    s_cmp_eq_u32 s28, 4
    s_cselect_b32 s60, s3, s7
    s_cselect_b32 s58, 0x800000, s18
    s_lshr_b32 s3, s2, 5
    s_lshl_b32 s3, s3, 3
    s_and_b32 s4, s2, 7
    s_or_b32 s3, s3, s4
    s_lshl_b32 s3, s3, 2
    s_add_u32 s3, s3, s30
    s_lshl_b32 s3, s3, 15
    s_add_u32 s3, s3, 0x800000
    s_cmp_eq_u32 s28, 5
    s_cselect_b32 s60, s3, s60
    s_cselect_b32 s58, 0x1000000, s58
    s_mov_b32 s59, 0x20000
    s_lshl_b32 s3, s33, 3
    s_xor_b32 s3, s3, 0x200000
    s_add_u32 s3, s3, s31
    s_cmp_eq_u32 s28, 7
    s_cselect_b32 s60, s3, s60
    s_cselect_b32 s58, 0x800000, s58
    s_mov_b32 m0, s32
    s_cmp_lt_u32 s28, 6
    s_cbranch_scc1 Lnp
    s_setprio 1
Lnp:
    s_mov_b32 s14, 0x80000
    s_cselect_b32 s10, 0x800000, s14
    s_mov_b32 s11, 0x20000
    s_waitcnt lgkmcnt(0)
    s_cselect_b32 s8, s36, s40
    s_cselect_b32 s9, s37, s41
    buffer_load_dwordx4 v4, s[8:11], s33 offen offset:0 lds
    buffer_load_dwordx4 v5, s[8:11], s33 offen offset:1024 lds
    buffer_load_dwordx4 v6, s[8:11], s33 offen offset:2048 lds
    buffer_load_dwordx4 v7, s[8:11], s33 offen offset:3072 lds
    s_mov_b32 s12, s40
    s_mov_b32 s13, s41
    s_mov_b32 s64, s50
    s_mov_b32 s65, s51
    s_load_dword s73, s[38:39], 0
    s_add_u32 m0, s32, 4096
    s_add_u32 s33, s33, s5
    buffer_load_dwordx4 v4, s[8:11], s33 offen offset:0 lds
    buffer_load_dwordx4 v5, s[8:11], s33 offen offset:1024 lds
    buffer_load_dwordx4 v6, s[8:11], s33 offen offset:2048 lds
    buffer_load_dwordx4 v7, s[8:11], s33 offen offset:3072 lds
    s_mov_b32 s20, s42
    s_mov_b32 s21, s43
    s_add_u32 m0, s32, 37888
    s_lshl_b32 s3, s30, 8
    buffer_load_dword v10, s[20:23], s3 offen lds
    s_mov_b64 exec, 0xffff
    buffer_load_dword v17, v16, s[64:67], 0 offen sc1
    s_mov_b64 exec, -1
    s_cmp_eq_u32 s28, 4
    s_cselect_b32 s56, s46, s44
    s_cselect_b32 s57, s47, s45
    s_cmp_eq_u32 s28, 5
    s_cselect_b32 s56, s50, s56
    s_cselect_b32 s57, s51, s57
    s_cmp_eq_u32 s28, 7
    s_cselect_b32 s56, s36, s56
    s_cselect_b32 s57, s37, s57
    s_mov_b64 exec, 1
    buffer_load_dword v13, off, s[56:59], s60
    s_mov_b64 exec, -1
    s_waitcnt vmcnt(7)
    s_barrier
    s_add_u32 m0, s32, 8192
    s_add_u32 s33, s33, s5
    buffer_load_dwordx4 v4, s[8:11], s33 offen offset:0 lds
    buffer_load_dwordx4 v5, s[8:11], s33 offen offset:1024 lds
    buffer_load_dwordx4 v6, s[8:11], s33 offen offset:2048 lds
    buffer_load_dwordx4 v7, s[8:11], s33 offen offset:3072 lds
    s_mov_b32 s16, s44
    s_mov_b32 s17, s45
    s_mov_b32 s26, 0
    s_add_u32 s40, s50, 0x800000
    s_addc_u32 s41, s51, 0
    s_mov_b32 s42, 0x800000
    s_mov_b32 s43, 0x20000
    s_lshr_b32 s3, s2, 5
    s_lshl_b32 s3, s3, 3
    s_and_b32 s4, s2, 7
    s_or_b32 s3, s3, s4
    s_lshl_b32 s3, s3, 17
    v_lshl_add_u32 v9, v1, 4, s3
    s_lshl_b32 s47, s30, 15
    s_lshl_b32 s3, s54, 14
    s_add_u32 s47, s47, s3
    s_cmp_ge_u32 s28, 6
    s_cbranch_scc1 Lwload
    s_getreg_b32 s24, hwreg(HW_REG_XCC_ID)
    s_and_b32 s24, s24, 15
    s_waitcnt vmcnt(6)
    s_barrier
    s_add_u32 m0, s32, 12288
    s_add_u32 s33, s33, s5
    buffer_load_dwordx4 v4, s[8:11], s33 offen offset:0 lds
    buffer_load_dwordx4 v5, s[8:11], s33 offen offset:1024 lds
    buffer_load_dwordx4 v6, s[8:11], s33 offen offset:2048 lds
    buffer_load_dwordx4 v7, s[8:11], s33 offen offset:3072 lds
    s_waitcnt vmcnt(4)
    s_barrier
    s_add_u32 m0, s32, 16384
    s_add_u32 s33, s33, s34
    s_and_b32 s33, s33, s35
    buffer_load_dwordx4 v4, s[8:11], s33 offen offset:0 lds
    buffer_load_dwordx4 v5, s[8:11], s33 offen offset:1024 lds
    buffer_load_dwordx4 v6, s[8:11], s33 offen offset:2048 lds
    buffer_load_dwordx4 v7, s[8:11], s33 offen offset:3072 lds
    s_add_u32 m0, s32, 20480
    s_add_u32 s33, s33, s5
    buffer_load_dwordx4 v4, s[8:11], s33 offen offset:0 lds
    buffer_load_dwordx4 v5, s[8:11], s33 offen offset:1024 lds
    buffer_load_dwordx4 v6, s[8:11], s33 offen offset:2048 lds
    buffer_load_dwordx4 v7, s[8:11], s33 offen offset:3072 lds
    s_waitcnt vmcnt(8)
    s_barrier
    s_add_u32 m0, s32, 24576
    s_add_u32 s33, s33, s5
    buffer_load_dwordx4 v4, s[8:11], s33 offen offset:0 lds
    buffer_load_dwordx4 v5, s[8:11], s33 offen offset:1024 lds
    buffer_load_dwordx4 v6, s[8:11], s33 offen offset:2048 lds
    buffer_load_dwordx4 v7, s[8:11], s33 offen offset:3072 lds
    s_waitcnt vmcnt(8)
    s_barrier
    s_add_u32 m0, s32, 28672
    s_add_u32 s33, s33, s5
    buffer_load_dwordx4 v4, s[8:11], s33 offen offset:0 lds
    buffer_load_dwordx4 v5, s[8:11], s33 offen offset:1024 lds
    buffer_load_dwordx4 v6, s[8:11], s33 offen offset:2048 lds
    buffer_load_dwordx4 v7, s[8:11], s33 offen offset:3072 lds
    s_waitcnt vmcnt(8)
    s_barrier
    s_add_u32 m0, s32, 32768
    s_add_u32 s33, s33, s34
    s_and_b32 s33, s33, s35
    buffer_load_dwordx4 v4, s[8:11], s33 offen offset:0 lds
    buffer_load_dwordx4 v5, s[8:11], s33 offen offset:1024 lds
    buffer_load_dwordx4 v6, s[8:11], s33 offen offset:2048 lds
    buffer_load_dwordx4 v7, s[8:11], s33 offen offset:3072 lds
    s_waitcnt vmcnt(8)
    s_barrier
    s_add_u32 m0, s32, 36864
    s_add_u32 s33, s33, s5
    buffer_load_dwordx4 v4, s[8:11], s33 offen offset:0 lds
    buffer_load_dwordx4 v5, s[8:11], s33 offen offset:1024 lds
    buffer_load_dwordx4 v6, s[8:11], s33 offen offset:2048 lds
    buffer_load_dwordx4 v7, s[8:11], s33 offen offset:3072 lds
    s_waitcnt vmcnt(8)
    s_barrier
    s_add_u32 m0, s32, 0
    s_add_u32 s33, s33, s5
    buffer_load_dwordx4 v4, s[8:11], s33 offen offset:0 lds
    buffer_load_dwordx4 v5, s[8:11], s33 offen offset:1024 lds
    buffer_load_dwordx4 v6, s[8:11], s33 offen offset:2048 lds
    buffer_load_dwordx4 v7, s[8:11], s33 offen offset:3072 lds
    s_waitcnt vmcnt(8)
    s_barrier
    s_add_u32 m0, s32, 4096
    s_add_u32 s33, s33, s5
    buffer_load_dwordx4 v4, s[8:11], s33 offen offset:0 lds
    buffer_load_dwordx4 v5, s[8:11], s33 offen offset:1024 lds
    buffer_load_dwordx4 v6, s[8:11], s33 offen offset:2048 lds
    buffer_load_dwordx4 v7, s[8:11], s33 offen offset:3072 lds
    s_waitcnt vmcnt(8)
    s_barrier
    s_add_u32 m0, s32, 8192
    s_add_u32 s33, s33, s34
    s_and_b32 s33, s33, s35
    buffer_load_dwordx4 v4, s[8:11], s33 offen offset:0 lds
    buffer_load_dwordx4 v5, s[8:11], s33 offen offset:1024 lds
    buffer_load_dwordx4 v6, s[8:11], s33 offen offset:2048 lds
    buffer_load_dwordx4 v7, s[8:11], s33 offen offset:3072 lds
    s_waitcnt vmcnt(8)
    s_barrier
    s_add_u32 m0, s32, 12288
    s_add_u32 s33, s33, s5
    buffer_load_dwordx4 v4, s[8:11], s33 offen offset:0 lds
    buffer_load_dwordx4 v5, s[8:11], s33 offen offset:1024 lds
    buffer_load_dwordx4 v6, s[8:11], s33 offen offset:2048 lds
    buffer_load_dwordx4 v7, s[8:11], s33 offen offset:3072 lds
    s_waitcnt vmcnt(8)
    s_barrier
    s_add_u32 m0, s32, 16384
    s_add_u32 s33, s33, s5
    buffer_load_dwordx4 v4, s[8:11], s33 offen offset:0 lds
    buffer_load_dwordx4 v5, s[8:11], s33 offen offset:1024 lds
    buffer_load_dwordx4 v6, s[8:11], s33 offen offset:2048 lds
    buffer_load_dwordx4 v7, s[8:11], s33 offen offset:3072 lds
    s_waitcnt vmcnt(8)
    s_barrier
    s_add_u32 m0, s32, 20480
    s_add_u32 s33, s33, s5
    buffer_load_dwordx4 v4, s[8:11], s33 offen offset:0 lds
    buffer_load_dwordx4 v5, s[8:11], s33 offen offset:1024 lds
    buffer_load_dwordx4 v6, s[8:11], s33 offen offset:2048 lds
    buffer_load_dwordx4 v7, s[8:11], s33 offen offset:3072 lds
    s_waitcnt vmcnt(8)
    s_barrier
    buffer_load_dword v13, v8, s[16:19], s7 offen
    s_waitcnt vmcnt(1)
    s_barrier
    v_add_u32 v19, 64, v17
    v_and_b32 v19, 0xffffffc0, v19
    v_or_b32 v19, s24, v19
    s_barrier
    s_mov_b64 exec, 0x3330
    s_mov_b32 s25, 0
Lsp0:
    buffer_load_dword v18, v16, s[64:67], 0 offen sc1
    s_add_u32 s25, s25, 1
    s_cmp_gt_u32 s25, 12
    s_cbranch_scc1 Lretry0
    s_waitcnt vmcnt(0)
    v_cmp_ne_u32 vcc, v18, v17
    v_and_b32 v21, 15, v18
    s_or_b32 s3, s24, 0
    v_cmp_eq_u32 s[44:45], s3, v21
    s_and_b32 s44, s44, vcc_lo
    s_cmp_eq_u32 s44, 0x3330
    s_cbranch_scc0 Lsp0
Lgot0:
    s_mov_b64 exec, -1
    s_add_u32 m0, s32, 0
    s_add_u32 s33, s47, 32768
    s_and_b32 s33, s33, 0x1ffff
    buffer_load_dwordx4 v9, s[40:43], s33 offen offset:0 sc1 lds
    buffer_load_dwordx4 v9, s[40:43], s33 offen offset:1024 sc1 lds
    buffer_load_dwordx4 v9, s[40:43], s33 offen offset:2048 sc1 lds
    buffer_load_dwordx4 v9, s[40:43], s33 offen offset:3072 sc1 lds
    s_add_u32 m0, s32, 4096
    s_add_u32 s33, s47, 40960
    s_and_b32 s33, s33, 0x1ffff
    buffer_load_dwordx4 v9, s[40:43], s33 offen offset:0 sc1 lds
    buffer_load_dwordx4 v9, s[40:43], s33 offen offset:1024 sc1 lds
    buffer_load_dwordx4 v9, s[40:43], s33 offen offset:2048 sc1 lds
    buffer_load_dwordx4 v9, s[40:43], s33 offen offset:3072 sc1 lds
    s_add_u32 m0, s32, 8192
    s_add_u32 s33, s47, 65536
    s_and_b32 s33, s33, 0x1ffff
    buffer_load_dwordx4 v9, s[40:43], s33 offen offset:0 sc1 lds
    buffer_load_dwordx4 v9, s[40:43], s33 offen offset:1024 sc1 lds
    buffer_load_dwordx4 v9, s[40:43], s33 offen offset:2048 sc1 lds
    buffer_load_dwordx4 v9, s[40:43], s33 offen offset:3072 sc1 lds
    s_add_u32 m0, s32, 12288
    s_add_u32 s33, s47, 73728
    s_and_b32 s33, s33, 0x1ffff
    buffer_load_dwordx4 v9, s[40:43], s33 offen offset:0 sc1 lds
    buffer_load_dwordx4 v9, s[40:43], s33 offen offset:1024 sc1 lds
    buffer_load_dwordx4 v9, s[40:43], s33 offen offset:2048 sc1 lds
    buffer_load_dwordx4 v9, s[40:43], s33 offen offset:3072 sc1 lds
    s_waitcnt vmcnt(12)
    s_barrier
    s_mov_b64 exec, 4
    buffer_store_dword v19, v16, s[64:67], 0 offen
    s_mov_b64 exec, -1
    s_add_u32 m0, s32, 16384
    s_add_u32 s33, s47, 98304
    s_and_b32 s33, s33, 0x1ffff
    buffer_load_dwordx4 v9, s[40:43], s33 offen offset:0 sc1 lds
    buffer_load_dwordx4 v9, s[40:43], s33 offen offset:1024 sc1 lds
    buffer_load_dwordx4 v9, s[40:43], s33 offen offset:2048 sc1 lds
    buffer_load_dwordx4 v9, s[40:43], s33 offen offset:3072 sc1 lds
    s_waitcnt vmcnt(12)
    s_barrier
    s_mov_b64 exec, 0x3330
    buffer_load_dword v18, v16, s[64:67], 0 offen sc1
    s_mov_b64 exec, -1
    s_add_u32 m0, s32, 20480
    s_add_u32 s33, s47, 106496
    s_and_b32 s33, s33, 0x1ffff
    buffer_load_dwordx4 v9, s[40:43], s33 offen offset:0 sc1 lds
    buffer_load_dwordx4 v9, s[40:43], s33 offen offset:1024 sc1 lds
    buffer_load_dwordx4 v9, s[40:43], s33 offen offset:2048 sc1 lds
    buffer_load_dwordx4 v9, s[40:43], s33 offen offset:3072 sc1 lds
    s_waitcnt vmcnt(9)
    s_barrier
    s_waitcnt vmcnt(4)
    s_mov_b64 exec, 0x3330
    v_cmp_ne_u32 vcc, v18, v17
    v_and_b32 v21, 31, v18
    s_or_b32 s3, s24, 16
    v_cmp_eq_u32 s[44:45], s3, v21
    s_and_b32 s44, s44, vcc_lo
    s_cmp_eq_u32 s44, 0x3330
    s_cbranch_scc1 Lgot1
    s_mov_b32 s25, 0
Lsp1:
    buffer_load_dword v18, v16, s[64:67], 0 offen sc1
    s_add_u32 s25, s25, 1
    s_cmp_gt_u32 s25, 12
    s_cbranch_scc1 Lretry1
    s_waitcnt vmcnt(0)
    v_cmp_ne_u32 vcc, v18, v17
    v_and_b32 v21, 31, v18
    s_or_b32 s3, s24, 16
    v_cmp_eq_u32 s[44:45], s3, v21
    s_and_b32 s44, s44, vcc_lo
    s_cmp_eq_u32 s44, 0x3330
    s_cbranch_scc0 Lsp1
Lgot1:
    s_mov_b64 exec, -1
    s_add_u32 m0, s32, 24576
    s_add_u32 s33, s47, 36864
    s_and_b32 s33, s33, 0x1ffff
    buffer_load_dwordx4 v9, s[40:43], s33 offen offset:0 sc1 lds
    buffer_load_dwordx4 v9, s[40:43], s33 offen offset:1024 sc1 lds
    buffer_load_dwordx4 v9, s[40:43], s33 offen offset:2048 sc1 lds
    buffer_load_dwordx4 v9, s[40:43], s33 offen offset:3072 sc1 lds
    s_add_u32 m0, s32, 28672
    s_add_u32 s33, s47, 45056
    s_and_b32 s33, s33, 0x1ffff
    buffer_load_dwordx4 v9, s[40:43], s33 offen offset:0 sc1 lds
    buffer_load_dwordx4 v9, s[40:43], s33 offen offset:1024 sc1 lds
    buffer_load_dwordx4 v9, s[40:43], s33 offen offset:2048 sc1 lds
    buffer_load_dwordx4 v9, s[40:43], s33 offen offset:3072 sc1 lds
    s_waitcnt vmcnt(8)
    s_barrier
    s_add_u32 m0, s32, 32768
    s_add_u32 s33, s47, 69632
    s_and_b32 s33, s33, 0x1ffff
    buffer_load_dwordx4 v9, s[40:43], s33 offen offset:0 sc1 lds
    buffer_load_dwordx4 v9, s[40:43], s33 offen offset:1024 sc1 lds
    buffer_load_dwordx4 v9, s[40:43], s33 offen offset:2048 sc1 lds
    buffer_load_dwordx4 v9, s[40:43], s33 offen offset:3072 sc1 lds
    s_add_u32 m0, s32, 36864
    s_add_u32 s33, s47, 77824
    s_and_b32 s33, s33, 0x1ffff
    buffer_load_dwordx4 v9, s[40:43], s33 offen offset:0 sc1 lds
    buffer_load_dwordx4 v9, s[40:43], s33 offen offset:1024 sc1 lds
    buffer_load_dwordx4 v9, s[40:43], s33 offen offset:2048 sc1 lds
    buffer_load_dwordx4 v9, s[40:43], s33 offen offset:3072 sc1 lds
    s_waitcnt vmcnt(8)
    s_barrier
    s_add_u32 m0, s32, 0
    s_add_u32 s33, s47, 102400
    s_and_b32 s33, s33, 0x1ffff
    buffer_load_dwordx4 v9, s[40:43], s33 offen offset:0 sc1 lds
    buffer_load_dwordx4 v9, s[40:43], s33 offen offset:1024 sc1 lds
    buffer_load_dwordx4 v9, s[40:43], s33 offen offset:2048 sc1 lds
    buffer_load_dwordx4 v9, s[40:43], s33 offen offset:3072 sc1 lds
    s_add_u32 m0, s32, 4096
    s_add_u32 s33, s47, 110592
    s_and_b32 s33, s33, 0x1ffff
    buffer_load_dwordx4 v9, s[40:43], s33 offen offset:0 sc1 lds
    buffer_load_dwordx4 v9, s[40:43], s33 offen offset:1024 sc1 lds
    buffer_load_dwordx4 v9, s[40:43], s33 offen offset:2048 sc1 lds
    buffer_load_dwordx4 v9, s[40:43], s33 offen offset:3072 sc1 lds
    s_waitcnt vmcnt(8)
    s_barrier
    s_waitcnt vmcnt(0)
    s_barrier
    s_waitcnt lgkmcnt(0)
    s_endpgm
Lwload:
    s_waitcnt vmcnt(6)
    s_barrier
    s_add_u32 m0, s32, 12288
    s_add_u32 s33, s33, s5
    buffer_load_dwordx4 v4, s[8:11], s33 offen offset:0 lds
    buffer_load_dwordx4 v5, s[8:11], s33 offen offset:1024 lds
    buffer_load_dwordx4 v6, s[8:11], s33 offen offset:2048 lds
    buffer_load_dwordx4 v7, s[8:11], s33 offen offset:3072 lds
    s_waitcnt vmcnt(4)
    s_barrier
    s_add_u32 m0, s32, 16384
    s_add_u32 s33, s33, s34
    s_and_b32 s33, s33, s35
    buffer_load_dwordx4 v4, s[8:11], s33 offen offset:0 lds
    buffer_load_dwordx4 v5, s[8:11], s33 offen offset:1024 lds
    buffer_load_dwordx4 v6, s[8:11], s33 offen offset:2048 lds
    buffer_load_dwordx4 v7, s[8:11], s33 offen offset:3072 lds
    s_add_u32 m0, s32, 20480
    s_add_u32 s33, s33, s5
    buffer_load_dwordx4 v4, s[8:11], s33 offen offset:0 lds
    buffer_load_dwordx4 v5, s[8:11], s33 offen offset:1024 lds
    buffer_load_dwordx4 v6, s[8:11], s33 offen offset:2048 lds
    buffer_load_dwordx4 v7, s[8:11], s33 offen offset:3072 lds
    s_waitcnt vmcnt(8)
    s_barrier
    s_add_u32 m0, s32, 24576
    s_add_u32 s33, s33, s5
    buffer_load_dwordx4 v4, s[8:11], s33 offen offset:0 lds
    buffer_load_dwordx4 v5, s[8:11], s33 offen offset:1024 lds
    buffer_load_dwordx4 v6, s[8:11], s33 offen offset:2048 lds
    buffer_load_dwordx4 v7, s[8:11], s33 offen offset:3072 lds
    s_waitcnt vmcnt(8)
    s_barrier
    s_add_u32 m0, s32, 28672
    s_add_u32 s33, s33, s5
    buffer_load_dwordx4 v4, s[8:11], s33 offen offset:0 lds
    buffer_load_dwordx4 v5, s[8:11], s33 offen offset:1024 lds
    buffer_load_dwordx4 v6, s[8:11], s33 offen offset:2048 lds
    buffer_load_dwordx4 v7, s[8:11], s33 offen offset:3072 lds
    s_waitcnt vmcnt(8)
    s_barrier
    s_add_u32 m0, s32, 32768
    s_add_u32 s33, s33, s34
    s_and_b32 s33, s33, s35
    buffer_load_dwordx4 v4, s[8:11], s33 offen offset:0 lds
    buffer_load_dwordx4 v5, s[8:11], s33 offen offset:1024 lds
    buffer_load_dwordx4 v6, s[8:11], s33 offen offset:2048 lds
    buffer_load_dwordx4 v7, s[8:11], s33 offen offset:3072 lds
    s_waitcnt vmcnt(8)
    s_barrier
    s_add_u32 m0, s32, 36864
    s_add_u32 s33, s33, s5
    buffer_load_dwordx4 v4, s[8:11], s33 offen offset:0 lds
    buffer_load_dwordx4 v5, s[8:11], s33 offen offset:1024 lds
    buffer_load_dwordx4 v6, s[8:11], s33 offen offset:2048 lds
    buffer_load_dwordx4 v7, s[8:11], s33 offen offset:3072 lds
    s_waitcnt vmcnt(8)
    s_barrier
    s_add_u32 m0, s32, 0
    s_add_u32 s33, s33, s5
    buffer_load_dwordx4 v4, s[8:11], s33 offen offset:0 lds
    buffer_load_dwordx4 v5, s[8:11], s33 offen offset:1024 lds
    buffer_load_dwordx4 v6, s[8:11], s33 offen offset:2048 lds
    buffer_load_dwordx4 v7, s[8:11], s33 offen offset:3072 lds
    s_waitcnt vmcnt(8)
    s_barrier
    s_add_u32 m0, s32, 4096
    s_add_u32 s33, s33, s5
    buffer_load_dwordx4 v4, s[8:11], s33 offen offset:0 lds
    buffer_load_dwordx4 v5, s[8:11], s33 offen offset:1024 lds
    buffer_load_dwordx4 v6, s[8:11], s33 offen offset:2048 lds
    buffer_load_dwordx4 v7, s[8:11], s33 offen offset:3072 lds
    s_waitcnt vmcnt(8)
    s_barrier
    s_add_u32 m0, s32, 8192
    s_add_u32 s33, s33, s34
    s_and_b32 s33, s33, s35
    buffer_load_dwordx4 v4, s[8:11], s33 offen offset:0 lds
    buffer_load_dwordx4 v5, s[8:11], s33 offen offset:1024 lds
    buffer_load_dwordx4 v6, s[8:11], s33 offen offset:2048 lds
    buffer_load_dwordx4 v7, s[8:11], s33 offen offset:3072 lds
    s_waitcnt vmcnt(8)
    s_barrier
    s_add_u32 m0, s32, 12288
    s_add_u32 s33, s33, s5
    buffer_load_dwordx4 v4, s[8:11], s33 offen offset:0 lds
    buffer_load_dwordx4 v5, s[8:11], s33 offen offset:1024 lds
    buffer_load_dwordx4 v6, s[8:11], s33 offen offset:2048 lds
    buffer_load_dwordx4 v7, s[8:11], s33 offen offset:3072 lds
    s_waitcnt vmcnt(8)
    s_barrier
    s_add_u32 m0, s32, 16384
    s_add_u32 s33, s33, s5
    buffer_load_dwordx4 v4, s[8:11], s33 offen offset:0 lds
    buffer_load_dwordx4 v5, s[8:11], s33 offen offset:1024 lds
    buffer_load_dwordx4 v6, s[8:11], s33 offen offset:2048 lds
    buffer_load_dwordx4 v7, s[8:11], s33 offen offset:3072 lds
    s_waitcnt vmcnt(8)
    s_barrier
    s_add_u32 m0, s32, 20480
    s_add_u32 s33, s33, s5
    buffer_load_dwordx4 v4, s[8:11], s33 offen offset:0 lds
    buffer_load_dwordx4 v5, s[8:11], s33 offen offset:1024 lds
    buffer_load_dwordx4 v6, s[8:11], s33 offen offset:2048 lds
    buffer_load_dwordx4 v7, s[8:11], s33 offen offset:3072 lds
    s_waitcnt vmcnt(8)
    s_barrier
    buffer_load_dword v13, v8, s[16:19], s7 offen
    s_waitcnt vmcnt(1)
    s_barrier
    s_add_u32 m0, s32, 24576
    v_subrev_u32 v6, 49152, v6
    v_subrev_u32 v7, 49152, v7
    s_add_u32 s33, s55, 0
    s_and_b32 s33, s33, s35
    buffer_load_dwordx4 v4, s[16:19], s33 offen offset:0 lds
    buffer_load_dwordx4 v5, s[16:19], s33 offen offset:1024 lds
    buffer_load_dwordx4 v6, s[16:19], s33 offen offset:2048 lds
    buffer_load_dwordx4 v7, s[16:19], s33 offen offset:3072 lds
    s_add_u32 m0, s32, 28672
    s_add_u32 s33, s55, 32768
    s_and_b32 s33, s33, s35
    buffer_load_dwordx4 v4, s[16:19], s33 offen offset:0 lds
    buffer_load_dwordx4 v5, s[16:19], s33 offen offset:1024 lds
    buffer_load_dwordx4 v6, s[16:19], s33 offen offset:2048 lds
    buffer_load_dwordx4 v7, s[16:19], s33 offen offset:3072 lds
    s_add_u32 m0, s32, 32768
    s_add_u32 s33, s55, 65536
    s_and_b32 s33, s33, s35
    buffer_load_dwordx4 v4, s[16:19], s33 offen offset:0 lds
    buffer_load_dwordx4 v5, s[16:19], s33 offen offset:1024 lds
    buffer_load_dwordx4 v6, s[16:19], s33 offen offset:2048 lds
    buffer_load_dwordx4 v7, s[16:19], s33 offen offset:3072 lds
    s_add_u32 m0, s32, 36864
    s_add_u32 s33, s55, 98304
    s_and_b32 s33, s33, s35
    buffer_load_dwordx4 v4, s[16:19], s33 offen offset:0 lds
    buffer_load_dwordx4 v5, s[16:19], s33 offen offset:1024 lds
    buffer_load_dwordx4 v6, s[16:19], s33 offen offset:2048 lds
    buffer_load_dwordx4 v7, s[16:19], s33 offen offset:3072 lds
    s_add_u32 m0, s32, 0
    s_add_u32 s33, s55, 131072
    s_and_b32 s33, s33, s35
    buffer_load_dwordx4 v4, s[16:19], s33 offen offset:0 lds
    buffer_load_dwordx4 v5, s[16:19], s33 offen offset:1024 lds
    buffer_load_dwordx4 v6, s[16:19], s33 offen offset:2048 lds
    buffer_load_dwordx4 v7, s[16:19], s33 offen offset:3072 lds
    s_add_u32 m0, s32, 4096
    s_add_u32 s33, s55, 196608
    s_and_b32 s33, s33, s35
    buffer_load_dwordx4 v4, s[16:19], s33 offen offset:0 lds
    buffer_load_dwordx4 v5, s[16:19], s33 offen offset:1024 lds
    buffer_load_dwordx4 v6, s[16:19], s33 offen offset:2048 lds
    buffer_load_dwordx4 v7, s[16:19], s33 offen offset:3072 lds
    s_waitcnt vmcnt(8)
    s_setprio 0
    s_barrier
    s_add_u32 m0, s32, 8192
    s_add_u32 s33, s55, 262144
    s_and_b32 s33, s33, s35
    buffer_load_dwordx4 v4, s[16:19], s33 offen offset:0 lds
    buffer_load_dwordx4 v5, s[16:19], s33 offen offset:1024 lds
    buffer_load_dwordx4 v6, s[16:19], s33 offen offset:2048 lds
    buffer_load_dwordx4 v7, s[16:19], s33 offen offset:3072 lds
    s_add_u32 m0, s32, 12288
    s_add_u32 s33, s55, 327680
    s_and_b32 s33, s33, s35
    buffer_load_dwordx4 v4, s[16:19], s33 offen offset:0 lds
    buffer_load_dwordx4 v5, s[16:19], s33 offen offset:1024 lds
    buffer_load_dwordx4 v6, s[16:19], s33 offen offset:2048 lds
    buffer_load_dwordx4 v7, s[16:19], s33 offen offset:3072 lds
    s_add_u32 m0, s32, 16384
    s_add_u32 s33, s55, 393216
    s_and_b32 s33, s33, s35
    buffer_load_dwordx4 v4, s[16:19], s33 offen offset:0 lds
    buffer_load_dwordx4 v5, s[16:19], s33 offen offset:1024 lds
    buffer_load_dwordx4 v6, s[16:19], s33 offen offset:2048 lds
    buffer_load_dwordx4 v7, s[16:19], s33 offen offset:3072 lds
    s_add_u32 m0, s32, 20480
    s_add_u32 s33, s55, 458752
    s_and_b32 s33, s33, s35
    buffer_load_dwordx4 v4, s[16:19], s33 offen offset:0 lds
    buffer_load_dwordx4 v5, s[16:19], s33 offen offset:1024 lds
    buffer_load_dwordx4 v6, s[16:19], s33 offen offset:2048 lds
    buffer_load_dwordx4 v7, s[16:19], s33 offen offset:3072 lds
    s_waitcnt vmcnt(20)
    s_barrier
    s_add_u32 m0, s32, 24576
    s_add_u32 s33, s55, 163840
    s_and_b32 s33, s33, s35
    buffer_load_dwordx4 v4, s[16:19], s33 offen offset:0 lds
    buffer_load_dwordx4 v5, s[16:19], s33 offen offset:1024 lds
    buffer_load_dwordx4 v6, s[16:19], s33 offen offset:2048 lds
    buffer_load_dwordx4 v7, s[16:19], s33 offen offset:3072 lds
    s_waitcnt vmcnt(20)
    s_barrier
    s_add_u32 m0, s32, 28672
    s_add_u32 s33, s55, 229376
    s_and_b32 s33, s33, s35
    buffer_load_dwordx4 v4, s[16:19], s33 offen offset:0 lds
    buffer_load_dwordx4 v5, s[16:19], s33 offen offset:1024 lds
    buffer_load_dwordx4 v6, s[16:19], s33 offen offset:2048 lds
    buffer_load_dwordx4 v7, s[16:19], s33 offen offset:3072 lds
    s_waitcnt vmcnt(16)
    s_barrier
    s_add_u32 m0, s32, 32768
    s_add_u32 s33, s55, 294912
    s_and_b32 s33, s33, s35
    buffer_load_dwordx4 v4, s[16:19], s33 offen offset:0 lds
    buffer_load_dwordx4 v5, s[16:19], s33 offen offset:1024 lds
    buffer_load_dwordx4 v6, s[16:19], s33 offen offset:2048 lds
    buffer_load_dwordx4 v7, s[16:19], s33 offen offset:3072 lds
    s_add_u32 m0, s32, 36864
    s_add_u32 s33, s55, 360448
    s_and_b32 s33, s33, s35
    buffer_load_dwordx4 v4, s[16:19], s33 offen offset:0 lds
    buffer_load_dwordx4 v5, s[16:19], s33 offen offset:1024 lds
    buffer_load_dwordx4 v6, s[16:19], s33 offen offset:2048 lds
    buffer_load_dwordx4 v7, s[16:19], s33 offen offset:3072 lds
    s_waitcnt vmcnt(16)
    s_barrier
    s_add_u32 m0, s32, 0
    s_add_u32 s33, s55, 425984
    s_and_b32 s33, s33, s35
    buffer_load_dwordx4 v4, s[16:19], s33 offen offset:0 lds
    buffer_load_dwordx4 v5, s[16:19], s33 offen offset:1024 lds
    buffer_load_dwordx4 v6, s[16:19], s33 offen offset:2048 lds
    buffer_load_dwordx4 v7, s[16:19], s33 offen offset:3072 lds
    s_add_u32 m0, s32, 4096
    s_add_u32 s33, s55, 491520
    s_and_b32 s33, s33, s35
    buffer_load_dwordx4 v4, s[16:19], s33 offen offset:0 lds
    buffer_load_dwordx4 v5, s[16:19], s33 offen offset:1024 lds
    buffer_load_dwordx4 v6, s[16:19], s33 offen offset:2048 lds
    buffer_load_dwordx4 v7, s[16:19], s33 offen offset:3072 lds
    s_waitcnt vmcnt(16)
    s_barrier
    s_waitcnt vmcnt(8)
    s_barrier
    s_waitcnt vmcnt(0)
    s_barrier
    s_waitcnt lgkmcnt(0)
    s_endpgm
Lretry0:
    s_mov_b32 s27, -1
    s_branch Lretry
Lretry1:
    s_mov_b32 s27, 0
Lretry:
    s_mov_b32 s25, 0
Lr_loop:
    s_mov_b64 exec, 0xffff
    buffer_load_dword v18, v16, s[64:67], 0 offen sc1
    s_add_u32 s25, s25, 1
    s_waitcnt vmcnt(0)
    v_cmp_ne_u32 s[56:57], v18, v17
    v_and_b32 v21, 16, v18
    v_cmp_ne_u32 s[60:61], 0, v21
    v_and_b32 v21, 15, v18
    v_cmp_eq_u32 s[58:59], s24, v21
    s_cmp_lg_u32 s26, 0
    s_cbranch_scc1 Lr_chk
    s_and_b32 s3, s56, s60
    s_and_b32 s3, s3, 3
    s_cmp_lg_u32 s3, 3
    s_cbranch_scc1 Lr_again
    s_mov_b32 s26, 1
    s_mov_b64 exec, 8
    buffer_store_dword v19, v16, s[64:67], 0 offen sc1
Lr_chk:
    s_or_b32 s58, s58, 0x8888
    s_and_b32 s56, s56, s58
    s_or_b32 s45, s60, s27
    s_and_b32 s45, s45, s56
    s_lshr_b32 s3, s45, 1
    s_and_b32 s45, s45, s3
    s_lshr_b32 s3, s56, 2
    s_or_b32 s45, s45, s3
    s_lshr_b32 s3, s56, 3
    s_or_b32 s45, s45, s3
    s_and_b32 s45, s45, 0x1110
    s_cmp_eq_u32 s45, 0x1110
    s_cbranch_scc1 Lr_done
Lr_again:
    s_cmp_lt_u32 s25, 0x100000
    s_cbranch_scc1 Lr_loop
Lr_done:
    buffer_inv sc1
    s_mov_b64 exec, 8
    v_add_u32 v19, 64, v19
    buffer_store_dword v19, v16, s[64:67], 0 offen sc1
    s_waitcnt vmcnt(0)
    s_cmp_eq_u32 s27, 0
    s_cbranch_scc1 Lgot1
    s_branch Lgot0
.p2align 12
Lcons:
    s_sub_u32 s72, 4, s5
    s_and_b32 s72, s72, 3
    s_and_b32 s32, s28, 1
    s_lshr_b32 s33, s28, 1
    s_mul_i32 s34, s33, 40960
    s_mul_i32 s35, s32, 40960
    s_add_u32 s35, s35, 81920
    s_lshl_b32 s6, s30, 8
    s_lshl_b32 s3, s32, 7
    s_add_u32 s6, s6, s3
    s_lshl_b32 s6, s6, 12
    s_lshl_b32 s3, s33, 7
    s_add_u32 s6, s6, s3
    s_add_u32 s59, s6, s31
    s_lshl_b32 s65, s2, 8
    s_lshl_b32 s3, s33, 4
    s_add_u32 s65, s65, s3
    s_lshl_b32 s3, s32, 2
    s_add_u32 s65, s65, s3
    s_waitcnt lgkmcnt(0)
    s_load_dword s58, s[38:39], 0
    s_add_u32 s60, s50, 0x800000
    s_addc_u32 s61, s51, 0
    s_mov_b32 s62, 0x800000
    s_mov_b32 s63, 0x20000
    s_mov_b32 s68, s50
    s_mov_b32 s69, s51
    s_mov_b32 s70, 65536
    s_mov_b32 s71, 0x20000
    s_mov_b32 s20, s46
    s_mov_b32 s21, s47
    s_mov_b32 s22, 8388608
    s_mov_b32 s23, 0x20000
    s_mov_b64 exec, 1
    buffer_load_dword v16, off, s[68:71], s65 sc1
    s_mov_b64 exec, -1
    v_lshrrev_b32 v24, 2, v1
    v_bfe_u32 v25, v1, 1, 1
    v_and_b32 v26, 6, v24
    v_xor_b32 v25, v25, v26
    v_and_b32 v26, 1, v1
    v_lshlrev_b32 v26, 3, v26
    v_lshl_add_u32 v25, v25, 4, v26
    v_lshl_add_u32 v25, v24, 7, v25
    v_xor_b32 v26, 0, v25
    v_add_u32 v6, s34, v26
    v_add_u32 v2, s35, v26
    v_xor_b32 v26, 32, v25
    v_add_u32 v7, s34, v26
    v_add_u32 v3, s35, v26
    v_xor_b32 v26, 64, v25
    v_add_u32 v8, s34, v26
    v_add_u32 v4, s35, v26
    v_xor_b32 v26, 96, v25
    v_add_u32 v9, s34, v26
    v_add_u32 v5, s35, v26
    v_lshlrev_b32 v25, 4, v1
    v_add_u32 v10, s34, v25
    s_lshl_b32 s3, s32, 13
    v_add_u32 v11, s3, v10
    s_mul_i32 s4, s28, 40960
    s_add_u32 s4, s4, 8192
    v_add_u32 v13, s4, v25
    v_lshrrev_b32 v27, 4, v1
    v_and_b32 v28, 15, v1
    v_lshrrev_b32 v25, 1, v27
    v_and_b32 v26, 7, v28
    v_xor_b32 v25, v25, v26
    v_and_b32 v26, 1, v27
    v_lshlrev_b32 v26, 3, v26
    v_lshl_add_u32 v25, v25, 4, v26
    v_lshl_add_u32 v25, v28, 7, v25
    v_add_u32 v12, s4, v25
    v_lshl_add_u32 v17, v27, 4, s4
    v_lshl_add_u32 v18, v1, 3, s4
    s_lshl_b32 s3, s32, 7
    s_add_u32 s3, s3, s4
    v_and_b32 v19, 31, v1
    v_lshl_add_u32 v19, v19, 2, s3
    v_lshrrev_b32 v24, 3, v1
    v_and_b32 v25, 7, v1
    v_xor_b32 v26, v25, v24
    v_lshlrev_b32 v26, 4, v26
    v_lshl_add_u32 v14, v24, 13, v26
    v_lshrrev_b32 v25, 1, v28
    v_lshlrev_b32 v26, 1, v27
    v_sub_u32 v21, v25, v26
    v_and_b32 v26, 1, v28
    v_lshlrev_b32 v22, 4, v26
    v_lshlrev_b32 v15, 4, v1
    s_lshr_b32 s3, s2, 5
    s_lshl_b32 s3, s3, 3
    s_and_b32 s4, s2, 7
    s_or_b32 s3, s3, s4
    s_lshl_b32 s3, s3, 2
    s_add_u32 s3, s3, s30
    s_lshl_b32 s3, s3, 2
    s_add_u32 s3, s3, s28
    s_lshl_b32 s64, s3, 13
    s_getreg_b32 s66, hwreg(HW_REG_XCC_ID)
    s_and_b32 s66, s66, 15
    s_mov_b64 vcc, -1
    s_branch Lpg1
Lpr1:
    s_branch Lpg2
Lpr2:
    s_waitcnt lgkmcnt(0)
    s_lshl_b32 s3, s29, 4
    s_lshr_b32 s3, s58, s3
    s_lshl_b32 s3, s3, 16
    v_mov_b32 v168, s3
    v_mul_f32 v169, v168, v168
    v_cvt_pk_bf16_f32 v169, v169, v169
    v_lshlrev_b32 v169, 16, v169
    v_add_f32 v170, 0x3e800000, v169
    v_cvt_pk_bf16_f32 v170, v170, v170
    v_lshlrev_b32 v170, 16, v170
    v_sqrt_f32 v171, v170
    v_rcp_f32 v172, v170
    v_log_f32 v173, v168
    v_cvt_pk_bf16_f32 v171, v171, v171
    v_lshlrev_b32 v171, 16, v171
    v_cvt_pk_bf16_f32 v172, v172, v172
    v_lshlrev_b32 v172, 16, v172
    v_mul_f32 v172, 0x3e800000, v172
    v_mul_f32 v173, 0x3f317218, v173
    v_rcp_f32 v169, v171
    v_cvt_pk_bf16_f32 v173, v173, v173
    v_lshlrev_b32 v173, 16, v173
    v_readfirstlane_b32 s56, v172
    v_mul_f32 v20, 0x3e800000, v173
    v_mul_f32 v172, 0.5, v168
    v_mul_f32 v172, v172, v169
    v_cvt_pk_bf16_f32 v172, v172, v172
    v_lshlrev_b32 v172, 16, v172
    v_cvt_pk_bf16_f32 v169, v169, v169
    v_lshlrev_b32 v169, 16, v169
    v_rcp_f32 v172, v172
    v_mul_f32 v169, 0xbfb8aa3b, v169
    v_min_f32 v172, 0x7d000000, v172
    v_mul_f32 v172, 0xbfb8aa3b, v172
    v_readfirstlane_b32 s52, v169
    s_mov_b32 s57, s56
    v_readfirstlane_b32 s54, v172
    s_mov_b32 s53, s52
    s_mov_b32 s55, s54
    s_lshr_b32 s3, s56, 16
    v_lshlrev_b32 v22, v22, s3
    s_lshl_b32 s3, s32, 1
    v_cmp_gt_u32 vcc, 2, v21
    v_add_u32 v21, s3, v21
    s_nop 0
    v_cndmask_b32 v21, 63, v21, vcc
    v_cmp_eq_u32 vcc, 0, v21
    s_nop 1
    v_cndmask_b32 v176, 0, v22, vcc
    v_cmp_eq_u32 vcc, 1, v21
    s_nop 1
    v_cndmask_b32 v177, 0, v22, vcc
    v_cmp_eq_u32 vcc, 2, v21
    s_nop 1
    v_cndmask_b32 v178, 0, v22, vcc
    v_cmp_eq_u32 vcc, 3, v21
    s_nop 1
    v_cndmask_b32 v179, 0, v22, vcc
    v_xor_b32 v21, 32, v12
    v_xor_b32 v22, 64, v12
    v_xor_b32 v23, 96, v12
    s_mov_b64 vcc, 0
    s_barrier
    ds_read_b64_tr_b16 a[0:1], v2 offset:0
    ds_read_b64_tr_b16 a[2:3], v2 offset:2048
    ds_read_b64_tr_b16 a[16:17], v6 offset:0
    ds_read_b64_tr_b16 a[18:19], v6 offset:2048
    ds_read_b64_tr_b16 a[20:21], v7 offset:0
    ds_read_b64_tr_b16 a[22:23], v7 offset:2048
    ds_read_b64_tr_b16 a[24:25], v8 offset:0
    ds_read_b64_tr_b16 a[26:27], v8 offset:2048
    ds_read_b64_tr_b16 a[28:29], v9 offset:0
    ds_read_b64_tr_b16 a[30:31], v9 offset:2048
    ds_read_b64_tr_b16 a[4:5], v3 offset:0
    ds_read_b64_tr_b16 a[6:7], v3 offset:2048
    ds_read_b64_tr_b16 a[8:9], v4 offset:0
    ds_read_b64_tr_b16 a[10:11], v4 offset:2048
    ds_read_b64_tr_b16 a[12:13], v5 offset:0
    ds_read_b64_tr_b16 a[14:15], v5 offset:2048
    s_waitcnt lgkmcnt(12)
    v_mfma_f32_16x16x32_bf16 v[24:27], a[0:3], a[16:19], 0
    s_barrier
    s_waitcnt lgkmcnt(10)
    v_mfma_f32_16x16x32_bf16 v[32:35], a[0:3], a[20:23], 0
    ds_read_b64_tr_b16 a[32:33], v2 offset:4096
    s_waitcnt lgkmcnt(9)
    v_mfma_f32_16x16x32_bf16 v[40:43], a[0:3], a[24:27], 0
    ds_read_b64_tr_b16 a[34:35], v2 offset:6144
    ds_read_b64_tr_b16 a[48:49], v6 offset:4096
    s_waitcnt lgkmcnt(9)
    v_mfma_f32_16x16x32_bf16 v[48:51], a[0:3], a[28:31], 0
    ds_read_b64_tr_b16 a[50:51], v6 offset:6144
    ds_read_b64_tr_b16 a[52:53], v7 offset:4096
    s_waitcnt lgkmcnt(5)
    v_mfma_f32_16x16x32_bf16 v[52:55], a[4:7], a[28:31], 0
    ds_read_b64_tr_b16 a[54:55], v7 offset:6144
    ds_read_b64_tr_b16 a[56:57], v8 offset:4096
    v_mfma_f32_16x16x32_bf16 v[44:47], a[4:7], a[24:27], 0
    ds_read_b64_tr_b16 a[58:59], v8 offset:6144
    v_mfma_f32_16x16x32_bf16 v[36:39], a[4:7], a[20:23], 0
    ds_read_b64_tr_b16 a[60:61], v9 offset:4096
    ds_read_b64_tr_b16 a[62:63], v9 offset:6144
    v_mfma_f32_16x16x32_bf16 v[28:31], a[4:7], a[16:19], 0
    ds_read_b64_tr_b16 a[36:37], v3 offset:4096
    ds_read_b64_tr_b16 a[38:39], v3 offset:6144
    v_mfma_f32_16x16x32_bf16 v[56:59], a[8:11], a[16:19], 0
    ds_read_b64_tr_b16 a[40:41], v4 offset:4096
    ds_read_b64_tr_b16 a[42:43], v4 offset:6144
    v_mfma_f32_16x16x32_bf16 v[64:67], a[8:11], a[20:23], 0
    ds_read_b64_tr_b16 a[44:45], v5 offset:4096
    ds_read_b64_tr_b16 a[46:47], v5 offset:6144
    v_mfma_f32_16x16x32_bf16 v[72:75], a[8:11], a[24:27], 0
    v_mfma_f32_16x16x32_bf16 v[80:83], a[8:11], a[28:31], 0
    v_mfma_f32_16x16x32_bf16 v[84:87], a[12:15], a[28:31], 0
    v_mfma_f32_16x16x32_bf16 v[76:79], a[12:15], a[24:27], 0
    v_mfma_f32_16x16x32_bf16 v[68:71], a[12:15], a[20:23], 0
    v_mfma_f32_16x16x32_bf16 v[60:63], a[12:15], a[16:19], 0
    s_cmp_lg_u32 s72, 0
    s_cbranch_scc1 Lres0
    v_mfma_f32_16x16x32_bf16 v[88:91], a[16:19], v[176:179], 0
    v_mfma_f32_16x16x32_bf16 v[92:95], a[20:23], v[176:179], 0
    v_mfma_f32_16x16x32_bf16 v[96:99], a[24:27], v[176:179], 0
    v_mfma_f32_16x16x32_bf16 v[100:103], a[28:31], v[176:179], 0
Lres0:
    ds_read_b32 v19, v19 offset:29696
    s_waitcnt lgkmcnt(0)
    v_lshlrev_b32 v168, 16, v19
    v_and_b32 v169, 0xffff0000, v19
    v_mul_f32 v168, v168, v20
    v_mul_f32 v169, v169, v20
    v_cvt_pk_bf16_f32 v170, v168, v169
    v_lshlrev_b32 v168, 16, v170
    v_and_b32 v169, 0xffff0000, v170
    v_mul_f32 v168, 0xbfb8aa3b, v168
    v_mul_f32 v169, 0xbfb8aa3b, v169
    ds_write_b64 v18, v[168:169] offset:28672
    ds_read_b128 v[152:155], v17 offset:28672
    ds_read_b128 v[156:159], v17 offset:28736
    ds_read_b128 v[160:163], v17 offset:28800
    ds_read_b128 v[164:167], v17 offset:28864
    v_mfma_f32_16x16x32_bf16 v[24:27], a[32:35], a[48:51], v[24:27]
    s_barrier
    v_mfma_f32_16x16x32_bf16 v[32:35], a[32:35], a[52:55], v[32:35]
    ds_read_b64_tr_b16 a[0:1], v2 offset:8192
    v_mfma_f32_16x16x32_bf16 v[40:43], a[32:35], a[56:59], v[40:43]
    ds_read_b64_tr_b16 a[2:3], v2 offset:10240
    ds_read_b64_tr_b16 a[16:17], v6 offset:8192
    v_mfma_f32_16x16x32_bf16 v[48:51], a[32:35], a[60:63], v[48:51]
    ds_read_b64_tr_b16 a[18:19], v6 offset:10240
    ds_read_b64_tr_b16 a[20:21], v7 offset:8192
    v_mfma_f32_16x16x32_bf16 v[52:55], a[36:39], a[60:63], v[52:55]
    ds_read_b64_tr_b16 a[22:23], v7 offset:10240
    ds_read_b64_tr_b16 a[24:25], v8 offset:8192
    v_mfma_f32_16x16x32_bf16 v[44:47], a[36:39], a[56:59], v[44:47]
    ds_read_b64_tr_b16 a[26:27], v8 offset:10240
    v_mfma_f32_16x16x32_bf16 v[36:39], a[36:39], a[52:55], v[36:39]
    ds_read_b64_tr_b16 a[28:29], v9 offset:8192
    ds_read_b64_tr_b16 a[30:31], v9 offset:10240
    v_mfma_f32_16x16x32_bf16 v[28:31], a[36:39], a[48:51], v[28:31]
    ds_read_b64_tr_b16 a[4:5], v3 offset:8192
    ds_read_b64_tr_b16 a[6:7], v3 offset:10240
    v_mfma_f32_16x16x32_bf16 v[56:59], a[40:43], a[48:51], v[56:59]
    ds_read_b64_tr_b16 a[8:9], v4 offset:8192
    ds_read_b64_tr_b16 a[10:11], v4 offset:10240
    v_mfma_f32_16x16x32_bf16 v[64:67], a[40:43], a[52:55], v[64:67]
    ds_read_b64_tr_b16 a[12:13], v5 offset:8192
    ds_read_b64_tr_b16 a[14:15], v5 offset:10240
    v_mfma_f32_16x16x32_bf16 v[72:75], a[40:43], a[56:59], v[72:75]
    v_mfma_f32_16x16x32_bf16 v[80:83], a[40:43], a[60:63], v[80:83]
    v_mfma_f32_16x16x32_bf16 v[84:87], a[44:47], a[60:63], v[84:87]
    v_mfma_f32_16x16x32_bf16 v[76:79], a[44:47], a[56:59], v[76:79]
    v_mfma_f32_16x16x32_bf16 v[68:71], a[44:47], a[52:55], v[68:71]
    v_mfma_f32_16x16x32_bf16 v[60:63], a[44:47], a[48:51], v[60:63]
    s_cmp_lg_u32 s72, 0
    s_cbranch_scc1 Lres1
    v_mfma_f32_16x16x32_bf16 v[104:107], a[48:51], v[176:179], 0
    v_mfma_f32_16x16x32_bf16 v[108:111], a[52:55], v[176:179], 0
    v_mfma_f32_16x16x32_bf16 v[112:115], a[56:59], v[176:179], 0
    v_mfma_f32_16x16x32_bf16 v[116:119], a[60:63], v[176:179], 0
Lres1:
    s_waitcnt lgkmcnt(6)
    v_mfma_f32_16x16x32_bf16 v[24:27], a[0:3], a[16:19], v[24:27]
    s_barrier
    v_mfma_f32_16x16x32_bf16 v[32:35], a[0:3], a[20:23], v[32:35]
    ds_read_b64_tr_b16 a[32:33], v2 offset:12288
    v_mfma_f32_16x16x32_bf16 v[40:43], a[0:3], a[24:27], v[40:43]
    ds_read_b64_tr_b16 a[34:35], v2 offset:14336
    ds_read_b64_tr_b16 a[48:49], v6 offset:12288
    v_mfma_f32_16x16x32_bf16 v[48:51], a[0:3], a[28:31], v[48:51]
    ds_read_b64_tr_b16 a[50:51], v6 offset:14336
    ds_read_b64_tr_b16 a[52:53], v7 offset:12288
    s_waitcnt lgkmcnt(5)
    v_mfma_f32_16x16x32_bf16 v[52:55], a[4:7], a[28:31], v[52:55]
    ds_read_b64_tr_b16 a[54:55], v7 offset:14336
    ds_read_b64_tr_b16 a[56:57], v8 offset:12288
    v_mfma_f32_16x16x32_bf16 v[44:47], a[4:7], a[24:27], v[44:47]
    ds_read_b64_tr_b16 a[58:59], v8 offset:14336
    v_mfma_f32_16x16x32_bf16 v[36:39], a[4:7], a[20:23], v[36:39]
    ds_read_b64_tr_b16 a[60:61], v9 offset:12288
    ds_read_b64_tr_b16 a[62:63], v9 offset:14336
    v_mfma_f32_16x16x32_bf16 v[28:31], a[4:7], a[16:19], v[28:31]
    ds_read_b64_tr_b16 a[36:37], v3 offset:12288
    ds_read_b64_tr_b16 a[38:39], v3 offset:14336
    v_mfma_f32_16x16x32_bf16 v[56:59], a[8:11], a[16:19], v[56:59]
    ds_read_b64_tr_b16 a[40:41], v4 offset:12288
    ds_read_b64_tr_b16 a[42:43], v4 offset:14336
    v_mfma_f32_16x16x32_bf16 v[64:67], a[8:11], a[20:23], v[64:67]
    ds_read_b64_tr_b16 a[44:45], v5 offset:12288
    ds_read_b64_tr_b16 a[46:47], v5 offset:14336
    v_mfma_f32_16x16x32_bf16 v[72:75], a[8:11], a[24:27], v[72:75]
    v_mfma_f32_16x16x32_bf16 v[80:83], a[8:11], a[28:31], v[80:83]
    v_mfma_f32_16x16x32_bf16 v[84:87], a[12:15], a[28:31], v[84:87]
    v_mfma_f32_16x16x32_bf16 v[76:79], a[12:15], a[24:27], v[76:79]
    v_mfma_f32_16x16x32_bf16 v[68:71], a[12:15], a[20:23], v[68:71]
    v_mfma_f32_16x16x32_bf16 v[60:63], a[12:15], a[16:19], v[60:63]
    s_cmp_lg_u32 s72, 0
    s_cbranch_scc1 Lres2
    v_mfma_f32_16x16x32_bf16 v[120:123], a[16:19], v[176:179], 0
    v_mfma_f32_16x16x32_bf16 v[124:127], a[20:23], v[176:179], 0
    v_mfma_f32_16x16x32_bf16 v[128:131], a[24:27], v[176:179], 0
    v_mfma_f32_16x16x32_bf16 v[132:135], a[28:31], v[176:179], 0
Lres2:
    s_waitcnt lgkmcnt(6)
    v_mfma_f32_16x16x32_bf16 v[24:27], a[32:35], a[48:51], v[24:27]
    s_barrier
    v_mfma_f32_16x16x32_bf16 v[32:35], a[32:35], a[52:55], v[32:35]
    ds_read_b64_tr_b16 a[0:1], v2 offset:16384
    v_mfma_f32_16x16x32_bf16 v[40:43], a[32:35], a[56:59], v[40:43]
    ds_read_b64_tr_b16 a[2:3], v2 offset:18432
    ds_read_b64_tr_b16 a[16:17], v6 offset:16384
    v_mfma_f32_16x16x32_bf16 v[48:51], a[32:35], a[60:63], v[48:51]
    ds_read_b64_tr_b16 a[18:19], v6 offset:18432
    ds_read_b64_tr_b16 a[20:21], v7 offset:16384
    s_waitcnt lgkmcnt(5)
    v_mfma_f32_16x16x32_bf16 v[52:55], a[36:39], a[60:63], v[52:55]
    ds_read_b64_tr_b16 a[22:23], v7 offset:18432
    ds_read_b64_tr_b16 a[24:25], v8 offset:16384
    v_mfma_f32_16x16x32_bf16 v[44:47], a[36:39], a[56:59], v[44:47]
    ds_read_b64_tr_b16 a[26:27], v8 offset:18432
    v_mfma_f32_16x16x32_bf16 v[36:39], a[36:39], a[52:55], v[36:39]
    ds_read_b64_tr_b16 a[28:29], v9 offset:16384
    ds_read_b64_tr_b16 a[30:31], v9 offset:18432
    v_mfma_f32_16x16x32_bf16 v[28:31], a[36:39], a[48:51], v[28:31]
    ds_read_b64_tr_b16 a[4:5], v3 offset:16384
    ds_read_b64_tr_b16 a[6:7], v3 offset:18432
    v_mfma_f32_16x16x32_bf16 v[56:59], a[40:43], a[48:51], v[56:59]
    ds_read_b64_tr_b16 a[8:9], v4 offset:16384
    ds_read_b64_tr_b16 a[10:11], v4 offset:18432
    v_mfma_f32_16x16x32_bf16 v[64:67], a[40:43], a[52:55], v[64:67]
    ds_read_b64_tr_b16 a[12:13], v5 offset:16384
    ds_read_b64_tr_b16 a[14:15], v5 offset:18432
    v_mfma_f32_16x16x32_bf16 v[72:75], a[40:43], a[56:59], v[72:75]
    v_mfma_f32_16x16x32_bf16 v[80:83], a[40:43], a[60:63], v[80:83]
    v_mfma_f32_16x16x32_bf16 v[84:87], a[44:47], a[60:63], v[84:87]
    v_mfma_f32_16x16x32_bf16 v[76:79], a[44:47], a[56:59], v[76:79]
    v_mfma_f32_16x16x32_bf16 v[68:71], a[44:47], a[52:55], v[68:71]
    v_mfma_f32_16x16x32_bf16 v[60:63], a[44:47], a[48:51], v[60:63]
    s_cmp_lg_u32 s72, 0
    s_cbranch_scc1 Lres3
    v_mfma_f32_16x16x32_bf16 v[136:139], a[48:51], v[176:179], 0
    v_mfma_f32_16x16x32_bf16 v[140:143], a[52:55], v[176:179], 0
    v_mfma_f32_16x16x32_bf16 v[144:147], a[56:59], v[176:179], 0
    v_mfma_f32_16x16x32_bf16 v[148:151], a[60:63], v[176:179], 0
Lres3:
    s_waitcnt vmcnt(0)
    v_add_u32 v16, 64, v16
    v_and_b32 v16, 0xffffffc0, v16
    v_or_b32 v16, s66, v16
    s_waitcnt lgkmcnt(6)
    v_mfma_f32_16x16x32_bf16 v[24:27], a[0:3], a[16:19], v[24:27]
    s_barrier
    v_mfma_f32_16x16x32_bf16 v[32:35], a[0:3], a[20:23], v[32:35]
    ds_read_b64_tr_b16 a[32:33], v2 offset:20480
    v_mfma_f32_16x16x32_bf16 v[40:43], a[0:3], a[24:27], v[40:43]
    ds_read_b64_tr_b16 a[34:35], v2 offset:22528
    ds_read_b64_tr_b16 a[48:49], v6 offset:20480
    v_mfma_f32_16x16x32_bf16 v[48:51], a[0:3], a[28:31], v[48:51]
    ds_read_b64_tr_b16 a[50:51], v6 offset:22528
    ds_read_b64_tr_b16 a[52:53], v7 offset:20480
    s_waitcnt lgkmcnt(5)
    v_mfma_f32_16x16x32_bf16 v[52:55], a[4:7], a[28:31], v[52:55]
    ds_read_b64_tr_b16 a[54:55], v7 offset:22528
    ds_read_b64_tr_b16 a[56:57], v8 offset:20480
    v_mfma_f32_16x16x32_bf16 v[44:47], a[4:7], a[24:27], v[44:47]
    ds_read_b64_tr_b16 a[58:59], v8 offset:22528
    v_mfma_f32_16x16x32_bf16 v[36:39], a[4:7], a[20:23], v[36:39]
    ds_read_b64_tr_b16 a[60:61], v9 offset:20480
    ds_read_b64_tr_b16 a[62:63], v9 offset:22528
    v_mfma_f32_16x16x32_bf16 v[28:31], a[4:7], a[16:19], v[28:31]
    ds_read_b64_tr_b16 a[36:37], v3 offset:20480
    ds_read_b64_tr_b16 a[38:39], v3 offset:22528
    v_mfma_f32_16x16x32_bf16 v[56:59], a[8:11], a[16:19], v[56:59]
    ds_read_b64_tr_b16 a[40:41], v4 offset:20480
    ds_read_b64_tr_b16 a[42:43], v4 offset:22528
    v_mfma_f32_16x16x32_bf16 v[64:67], a[8:11], a[20:23], v[64:67]
    ds_read_b64_tr_b16 a[44:45], v5 offset:20480
    ds_read_b64_tr_b16 a[46:47], v5 offset:22528
    v_mfma_f32_16x16x32_bf16 v[72:75], a[8:11], a[24:27], v[72:75]
    v_mfma_f32_16x16x32_bf16 v[80:83], a[8:11], a[28:31], v[80:83]
    v_mfma_f32_16x16x32_bf16 v[84:87], a[12:15], a[28:31], v[84:87]
    v_mfma_f32_16x16x32_bf16 v[76:79], a[12:15], a[24:27], v[76:79]
    v_mfma_f32_16x16x32_bf16 v[68:71], a[12:15], a[20:23], v[68:71]
    v_mfma_f32_16x16x32_bf16 v[60:63], a[12:15], a[16:19], v[60:63]
    s_cmp_lg_u32 s72, 1
    s_cbranch_scc1 Lres4
    v_mfma_f32_16x16x32_bf16 v[88:91], a[16:19], v[176:179], 0
    v_mfma_f32_16x16x32_bf16 v[92:95], a[20:23], v[176:179], 0
    v_mfma_f32_16x16x32_bf16 v[96:99], a[24:27], v[176:179], 0
    v_mfma_f32_16x16x32_bf16 v[100:103], a[28:31], v[176:179], 0
Lres4:
    s_waitcnt lgkmcnt(6)
    v_mfma_f32_16x16x32_bf16 v[24:27], a[32:35], a[48:51], v[24:27]
    s_barrier
    v_mfma_f32_16x16x32_bf16 v[32:35], a[32:35], a[52:55], v[32:35]
    ds_read_b64_tr_b16 a[0:1], v2 offset:24576
    v_mfma_f32_16x16x32_bf16 v[40:43], a[32:35], a[56:59], v[40:43]
    ds_read_b64_tr_b16 a[2:3], v2 offset:26624
    ds_read_b64_tr_b16 a[16:17], v6 offset:24576
    v_mfma_f32_16x16x32_bf16 v[48:51], a[32:35], a[60:63], v[48:51]
    ds_read_b64_tr_b16 a[18:19], v6 offset:26624
    ds_read_b64_tr_b16 a[20:21], v7 offset:24576
    s_waitcnt lgkmcnt(5)
    v_mfma_f32_16x16x32_bf16 v[52:55], a[36:39], a[60:63], v[52:55]
    ds_read_b64_tr_b16 a[22:23], v7 offset:26624
    ds_read_b64_tr_b16 a[24:25], v8 offset:24576
    v_mfma_f32_16x16x32_bf16 v[44:47], a[36:39], a[56:59], v[44:47]
    ds_read_b64_tr_b16 a[26:27], v8 offset:26624
    v_mfma_f32_16x16x32_bf16 v[36:39], a[36:39], a[52:55], v[36:39]
    ds_read_b64_tr_b16 a[28:29], v9 offset:24576
    ds_read_b64_tr_b16 a[30:31], v9 offset:26624
    v_mfma_f32_16x16x32_bf16 v[28:31], a[36:39], a[48:51], v[28:31]
    ds_read_b64_tr_b16 a[4:5], v3 offset:24576
    ds_read_b64_tr_b16 a[6:7], v3 offset:26624
    v_mfma_f32_16x16x32_bf16 v[56:59], a[40:43], a[48:51], v[56:59]
    ds_read_b64_tr_b16 a[8:9], v4 offset:24576
    ds_read_b64_tr_b16 a[10:11], v4 offset:26624
    v_mfma_f32_16x16x32_bf16 v[64:67], a[40:43], a[52:55], v[64:67]
    ds_read_b64_tr_b16 a[12:13], v5 offset:24576
    ds_read_b64_tr_b16 a[14:15], v5 offset:26624
    v_mfma_f32_16x16x32_bf16 v[72:75], a[40:43], a[56:59], v[72:75]
    v_mfma_f32_16x16x32_bf16 v[80:83], a[40:43], a[60:63], v[80:83]
    v_mfma_f32_16x16x32_bf16 v[84:87], a[44:47], a[60:63], v[84:87]
    v_mfma_f32_16x16x32_bf16 v[76:79], a[44:47], a[56:59], v[76:79]
    v_mfma_f32_16x16x32_bf16 v[68:71], a[44:47], a[52:55], v[68:71]
    v_mfma_f32_16x16x32_bf16 v[60:63], a[44:47], a[48:51], v[60:63]
    s_cmp_lg_u32 s72, 1
    s_cbranch_scc1 Lres5
    v_mfma_f32_16x16x32_bf16 v[104:107], a[48:51], v[176:179], 0
    v_mfma_f32_16x16x32_bf16 v[108:111], a[52:55], v[176:179], 0
    v_mfma_f32_16x16x32_bf16 v[112:115], a[56:59], v[176:179], 0
    v_mfma_f32_16x16x32_bf16 v[116:119], a[60:63], v[176:179], 0
Lres5:
    s_waitcnt lgkmcnt(6)
    v_mfma_f32_16x16x32_bf16 v[24:27], a[0:3], a[16:19], v[24:27]
    s_barrier
    v_mfma_f32_16x16x32_bf16 v[32:35], a[0:3], a[20:23], v[32:35]
    ds_read_b64_tr_b16 a[32:33], v2 offset:28672
    v_mfma_f32_16x16x32_bf16 v[40:43], a[0:3], a[24:27], v[40:43]
    ds_read_b64_tr_b16 a[34:35], v2 offset:30720
    ds_read_b64_tr_b16 a[48:49], v6 offset:28672
    v_mfma_f32_16x16x32_bf16 v[48:51], a[0:3], a[28:31], v[48:51]
    ds_read_b64_tr_b16 a[50:51], v6 offset:30720
    ds_read_b64_tr_b16 a[52:53], v7 offset:28672
    s_waitcnt lgkmcnt(5)
    v_mfma_f32_16x16x32_bf16 v[52:55], a[4:7], a[28:31], v[52:55]
    ds_read_b64_tr_b16 a[54:55], v7 offset:30720
    ds_read_b64_tr_b16 a[56:57], v8 offset:28672
    v_mfma_f32_16x16x32_bf16 v[44:47], a[4:7], a[24:27], v[44:47]
    ds_read_b64_tr_b16 a[58:59], v8 offset:30720
    v_mfma_f32_16x16x32_bf16 v[36:39], a[4:7], a[20:23], v[36:39]
    ds_read_b64_tr_b16 a[60:61], v9 offset:28672
    ds_read_b64_tr_b16 a[62:63], v9 offset:30720
    v_mfma_f32_16x16x32_bf16 v[28:31], a[4:7], a[16:19], v[28:31]
    ds_read_b64_tr_b16 a[36:37], v3 offset:28672
    ds_read_b64_tr_b16 a[38:39], v3 offset:30720
    v_mfma_f32_16x16x32_bf16 v[56:59], a[8:11], a[16:19], v[56:59]
    ds_read_b64_tr_b16 a[40:41], v4 offset:28672
    ds_read_b64_tr_b16 a[42:43], v4 offset:30720
    v_mfma_f32_16x16x32_bf16 v[64:67], a[8:11], a[20:23], v[64:67]
    ds_read_b64_tr_b16 a[44:45], v5 offset:28672
    ds_read_b64_tr_b16 a[46:47], v5 offset:30720
    v_mfma_f32_16x16x32_bf16 v[72:75], a[8:11], a[24:27], v[72:75]
    v_mfma_f32_16x16x32_bf16 v[80:83], a[8:11], a[28:31], v[80:83]
    v_mfma_f32_16x16x32_bf16 v[84:87], a[12:15], a[28:31], v[84:87]
    v_mfma_f32_16x16x32_bf16 v[76:79], a[12:15], a[24:27], v[76:79]
    v_mfma_f32_16x16x32_bf16 v[68:71], a[12:15], a[20:23], v[68:71]
    v_mfma_f32_16x16x32_bf16 v[60:63], a[12:15], a[16:19], v[60:63]
    s_cmp_lg_u32 s72, 1
    s_cbranch_scc1 Lres6
    v_mfma_f32_16x16x32_bf16 v[120:123], a[16:19], v[176:179], 0
    v_mfma_f32_16x16x32_bf16 v[124:127], a[20:23], v[176:179], 0
    v_mfma_f32_16x16x32_bf16 v[128:131], a[24:27], v[176:179], 0
    v_mfma_f32_16x16x32_bf16 v[132:135], a[28:31], v[176:179], 0
Lres6:
    s_waitcnt lgkmcnt(6)
    v_mfma_f32_16x16x32_bf16 v[24:27], a[32:35], a[48:51], v[24:27]
    s_barrier
    v_mfma_f32_16x16x32_bf16 v[32:35], a[32:35], a[52:55], v[32:35]
    ds_read_b64_tr_b16 a[0:1], v2 offset:32768
    v_mfma_f32_16x16x32_bf16 v[40:43], a[32:35], a[56:59], v[40:43]
    ds_read_b64_tr_b16 a[2:3], v2 offset:34816
    ds_read_b64_tr_b16 a[16:17], v6 offset:32768
    v_mfma_f32_16x16x32_bf16 v[48:51], a[32:35], a[60:63], v[48:51]
    ds_read_b64_tr_b16 a[18:19], v6 offset:34816
    ds_read_b64_tr_b16 a[20:21], v7 offset:32768
    s_waitcnt lgkmcnt(5)
    v_mfma_f32_16x16x32_bf16 v[52:55], a[36:39], a[60:63], v[52:55]
    ds_read_b64_tr_b16 a[22:23], v7 offset:34816
    ds_read_b64_tr_b16 a[24:25], v8 offset:32768
    v_mfma_f32_16x16x32_bf16 v[44:47], a[36:39], a[56:59], v[44:47]
    ds_read_b64_tr_b16 a[26:27], v8 offset:34816
    v_mfma_f32_16x16x32_bf16 v[36:39], a[36:39], a[52:55], v[36:39]
    ds_read_b64_tr_b16 a[28:29], v9 offset:32768
    ds_read_b64_tr_b16 a[30:31], v9 offset:34816
    v_mfma_f32_16x16x32_bf16 v[28:31], a[36:39], a[48:51], v[28:31]
    ds_read_b64_tr_b16 a[4:5], v3 offset:32768
    ds_read_b64_tr_b16 a[6:7], v3 offset:34816
    v_mfma_f32_16x16x32_bf16 v[56:59], a[40:43], a[48:51], v[56:59]
    ds_read_b64_tr_b16 a[8:9], v4 offset:32768
    ds_read_b64_tr_b16 a[10:11], v4 offset:34816
    v_mfma_f32_16x16x32_bf16 v[64:67], a[40:43], a[52:55], v[64:67]
    ds_read_b64_tr_b16 a[12:13], v5 offset:32768
    ds_read_b64_tr_b16 a[14:15], v5 offset:34816
    v_mfma_f32_16x16x32_bf16 v[72:75], a[40:43], a[56:59], v[72:75]
    v_mfma_f32_16x16x32_bf16 v[80:83], a[40:43], a[60:63], v[80:83]
    v_mfma_f32_16x16x32_bf16 v[84:87], a[44:47], a[60:63], v[84:87]
    v_mfma_f32_16x16x32_bf16 v[76:79], a[44:47], a[56:59], v[76:79]
    v_mfma_f32_16x16x32_bf16 v[68:71], a[44:47], a[52:55], v[68:71]
    v_mfma_f32_16x16x32_bf16 v[60:63], a[44:47], a[48:51], v[60:63]
    s_cmp_lg_u32 s72, 1
    s_cbranch_scc1 Lres7
    v_mfma_f32_16x16x32_bf16 v[136:139], a[48:51], v[176:179], 0
    v_mfma_f32_16x16x32_bf16 v[140:143], a[52:55], v[176:179], 0
    v_mfma_f32_16x16x32_bf16 v[144:147], a[56:59], v[176:179], 0
    v_mfma_f32_16x16x32_bf16 v[148:151], a[60:63], v[176:179], 0
Lres7:
    s_waitcnt lgkmcnt(6)
    v_mfma_f32_16x16x32_bf16 v[24:27], a[0:3], a[16:19], v[24:27]
    s_barrier
    v_mfma_f32_16x16x32_bf16 v[32:35], a[0:3], a[20:23], v[32:35]
    ds_read_b64_tr_b16 a[32:33], v2 offset:36864
    v_mfma_f32_16x16x32_bf16 v[40:43], a[0:3], a[24:27], v[40:43]
    ds_read_b64_tr_b16 a[34:35], v2 offset:38912
    ds_read_b64_tr_b16 a[48:49], v6 offset:36864
    v_mfma_f32_16x16x32_bf16 v[48:51], a[0:3], a[28:31], v[48:51]
    ds_read_b64_tr_b16 a[50:51], v6 offset:38912
    ds_read_b64_tr_b16 a[52:53], v7 offset:36864
    s_waitcnt lgkmcnt(5)
    v_mfma_f32_16x16x32_bf16 v[52:55], a[4:7], a[28:31], v[52:55]
    ds_read_b64_tr_b16 a[54:55], v7 offset:38912
    ds_read_b64_tr_b16 a[56:57], v8 offset:36864
    v_mfma_f32_16x16x32_bf16 v[44:47], a[4:7], a[24:27], v[44:47]
    ds_read_b64_tr_b16 a[58:59], v8 offset:38912
    v_mfma_f32_16x16x32_bf16 v[36:39], a[4:7], a[20:23], v[36:39]
    ds_read_b64_tr_b16 a[60:61], v9 offset:36864
    ds_read_b64_tr_b16 a[62:63], v9 offset:38912
    v_mfma_f32_16x16x32_bf16 v[28:31], a[4:7], a[16:19], v[28:31]
    ds_read_b64_tr_b16 a[36:37], v3 offset:36864
    ds_read_b64_tr_b16 a[38:39], v3 offset:38912
    v_mfma_f32_16x16x32_bf16 v[56:59], a[8:11], a[16:19], v[56:59]
    ds_read_b64_tr_b16 a[40:41], v4 offset:36864
    ds_read_b64_tr_b16 a[42:43], v4 offset:38912
    v_mfma_f32_16x16x32_bf16 v[64:67], a[8:11], a[20:23], v[64:67]
    ds_read_b64_tr_b16 a[44:45], v5 offset:36864
    ds_read_b64_tr_b16 a[46:47], v5 offset:38912
    v_mfma_f32_16x16x32_bf16 v[72:75], a[8:11], a[24:27], v[72:75]
    v_mfma_f32_16x16x32_bf16 v[80:83], a[8:11], a[28:31], v[80:83]
    v_mfma_f32_16x16x32_bf16 v[84:87], a[12:15], a[28:31], v[84:87]
    v_mfma_f32_16x16x32_bf16 v[76:79], a[12:15], a[24:27], v[76:79]
    v_mfma_f32_16x16x32_bf16 v[68:71], a[12:15], a[20:23], v[68:71]
    v_mfma_f32_16x16x32_bf16 v[60:63], a[12:15], a[16:19], v[60:63]
    s_cmp_lg_u32 s72, 2
    s_cbranch_scc1 Lres8
    v_mfma_f32_16x16x32_bf16 v[88:91], a[16:19], v[176:179], 0
    v_mfma_f32_16x16x32_bf16 v[92:95], a[20:23], v[176:179], 0
    v_mfma_f32_16x16x32_bf16 v[96:99], a[24:27], v[176:179], 0
    v_mfma_f32_16x16x32_bf16 v[100:103], a[28:31], v[176:179], 0
Lres8:
    s_waitcnt lgkmcnt(6)
    v_mfma_f32_16x16x32_bf16 v[24:27], a[32:35], a[48:51], v[24:27]
    s_barrier
    v_mfma_f32_16x16x32_bf16 v[32:35], a[32:35], a[52:55], v[32:35]
    ds_read_b64_tr_b16 a[0:1], v2 offset:0
    v_mfma_f32_16x16x32_bf16 v[40:43], a[32:35], a[56:59], v[40:43]
    ds_read_b64_tr_b16 a[2:3], v2 offset:2048
    ds_read_b64_tr_b16 a[16:17], v6 offset:0
    v_mfma_f32_16x16x32_bf16 v[48:51], a[32:35], a[60:63], v[48:51]
    ds_read_b64_tr_b16 a[18:19], v6 offset:2048
    ds_read_b64_tr_b16 a[20:21], v7 offset:0
    s_waitcnt lgkmcnt(5)
    v_mfma_f32_16x16x32_bf16 v[52:55], a[36:39], a[60:63], v[52:55]
    ds_read_b64_tr_b16 a[22:23], v7 offset:2048
    ds_read_b64_tr_b16 a[24:25], v8 offset:0
    v_mfma_f32_16x16x32_bf16 v[44:47], a[36:39], a[56:59], v[44:47]
    ds_read_b64_tr_b16 a[26:27], v8 offset:2048
    v_mfma_f32_16x16x32_bf16 v[36:39], a[36:39], a[52:55], v[36:39]
    ds_read_b64_tr_b16 a[28:29], v9 offset:0
    ds_read_b64_tr_b16 a[30:31], v9 offset:2048
    v_mfma_f32_16x16x32_bf16 v[28:31], a[36:39], a[48:51], v[28:31]
    ds_read_b64_tr_b16 a[4:5], v3 offset:0
    ds_read_b64_tr_b16 a[6:7], v3 offset:2048
    v_mfma_f32_16x16x32_bf16 v[56:59], a[40:43], a[48:51], v[56:59]
    ds_read_b64_tr_b16 a[8:9], v4 offset:0
    ds_read_b64_tr_b16 a[10:11], v4 offset:2048
    v_mfma_f32_16x16x32_bf16 v[64:67], a[40:43], a[52:55], v[64:67]
    ds_read_b64_tr_b16 a[12:13], v5 offset:0
    ds_read_b64_tr_b16 a[14:15], v5 offset:2048
    v_mfma_f32_16x16x32_bf16 v[72:75], a[40:43], a[56:59], v[72:75]
    v_mfma_f32_16x16x32_bf16 v[80:83], a[40:43], a[60:63], v[80:83]
Lpg1:
    s_cbranch_vccnz Lpr1
    s_nop 0
    v_mfma_f32_16x16x32_bf16 v[84:87], a[44:47], a[60:63], v[84:87]
    v_mfma_f32_16x16x32_bf16 v[76:79], a[44:47], a[56:59], v[76:79]
    v_mfma_f32_16x16x32_bf16 v[68:71], a[44:47], a[52:55], v[68:71]
    v_mfma_f32_16x16x32_bf16 v[60:63], a[44:47], a[48:51], v[60:63]
    s_cmp_lg_u32 s72, 2
    s_cbranch_scc1 Lres9
    v_mfma_f32_16x16x32_bf16 v[104:107], a[48:51], v[176:179], 0
    v_mfma_f32_16x16x32_bf16 v[108:111], a[52:55], v[176:179], 0
    v_mfma_f32_16x16x32_bf16 v[112:115], a[56:59], v[176:179], 0
    v_mfma_f32_16x16x32_bf16 v[116:119], a[60:63], v[176:179], 0
Lres9:
    s_waitcnt lgkmcnt(6)
    v_mfma_f32_16x16x32_bf16 v[24:27], a[0:3], a[16:19], v[24:27]
    s_barrier
    v_mfma_f32_16x16x32_bf16 v[32:35], a[0:3], a[20:23], v[32:35]
    ds_read_b64_tr_b16 a[32:33], v2 offset:4096
    v_mfma_f32_16x16x32_bf16 v[40:43], a[0:3], a[24:27], v[40:43]
    ds_read_b64_tr_b16 a[34:35], v2 offset:6144
    ds_read_b64_tr_b16 a[48:49], v6 offset:4096
    v_mfma_f32_16x16x32_bf16 v[48:51], a[0:3], a[28:31], v[48:51]
    ds_read_b64_tr_b16 a[50:51], v6 offset:6144
    ds_read_b64_tr_b16 a[52:53], v7 offset:4096
    s_waitcnt lgkmcnt(5)
    v_mfma_f32_16x16x32_bf16 v[52:55], a[4:7], a[28:31], v[52:55]
    ds_read_b64_tr_b16 a[54:55], v7 offset:6144
    ds_read_b64_tr_b16 a[56:57], v8 offset:4096
    v_mfma_f32_16x16x32_bf16 v[44:47], a[4:7], a[24:27], v[44:47]
    ds_read_b64_tr_b16 a[58:59], v8 offset:6144
    v_mfma_f32_16x16x32_bf16 v[36:39], a[4:7], a[20:23], v[36:39]
    ds_read_b64_tr_b16 a[60:61], v9 offset:4096
    ds_read_b64_tr_b16 a[62:63], v9 offset:6144
    v_mfma_f32_16x16x32_bf16 v[28:31], a[4:7], a[16:19], v[28:31]
    ds_read_b64_tr_b16 a[36:37], v3 offset:4096
    ds_read_b64_tr_b16 a[38:39], v3 offset:6144
    v_mfma_f32_16x16x32_bf16 v[56:59], a[8:11], a[16:19], v[56:59]
    ds_read_b64_tr_b16 a[40:41], v4 offset:4096
    ds_read_b64_tr_b16 a[42:43], v4 offset:6144
    v_mfma_f32_16x16x32_bf16 v[64:67], a[8:11], a[20:23], v[64:67]
    ds_read_b64_tr_b16 a[44:45], v5 offset:4096
    ds_read_b64_tr_b16 a[46:47], v5 offset:6144
    v_mfma_f32_16x16x32_bf16 v[72:75], a[8:11], a[24:27], v[72:75]
    v_mfma_f32_16x16x32_bf16 v[80:83], a[8:11], a[28:31], v[80:83]
    v_mfma_f32_16x16x32_bf16 v[84:87], a[12:15], a[28:31], v[84:87]
    v_mfma_f32_16x16x32_bf16 v[76:79], a[12:15], a[24:27], v[76:79]
    v_mfma_f32_16x16x32_bf16 v[68:71], a[12:15], a[20:23], v[68:71]
    v_mfma_f32_16x16x32_bf16 v[60:63], a[12:15], a[16:19], v[60:63]
    s_cmp_lg_u32 s72, 2
    s_cbranch_scc1 Lres10
    v_mfma_f32_16x16x32_bf16 v[120:123], a[16:19], v[176:179], 0
    v_mfma_f32_16x16x32_bf16 v[124:127], a[20:23], v[176:179], 0
    v_mfma_f32_16x16x32_bf16 v[128:131], a[24:27], v[176:179], 0
    v_mfma_f32_16x16x32_bf16 v[132:135], a[28:31], v[176:179], 0
Lres10:
    s_waitcnt lgkmcnt(6)
    v_mfma_f32_16x16x32_bf16 v[24:27], a[32:35], a[48:51], v[24:27]
    s_barrier
    v_mfma_f32_16x16x32_bf16 v[32:35], a[32:35], a[52:55], v[32:35]
    ds_read_b64_tr_b16 a[0:1], v2 offset:8192
    v_mfma_f32_16x16x32_bf16 v[40:43], a[32:35], a[56:59], v[40:43]
    ds_read_b64_tr_b16 a[2:3], v2 offset:10240
    ds_read_b64_tr_b16 a[16:17], v6 offset:8192
    v_mfma_f32_16x16x32_bf16 v[48:51], a[32:35], a[60:63], v[48:51]
    ds_read_b64_tr_b16 a[18:19], v6 offset:10240
    ds_read_b64_tr_b16 a[20:21], v7 offset:8192
    s_waitcnt lgkmcnt(5)
    v_mfma_f32_16x16x32_bf16 v[52:55], a[36:39], a[60:63], v[52:55]
    ds_read_b64_tr_b16 a[22:23], v7 offset:10240
    ds_read_b64_tr_b16 a[24:25], v8 offset:8192
    v_mfma_f32_16x16x32_bf16 v[44:47], a[36:39], a[56:59], v[44:47]
    ds_read_b64_tr_b16 a[26:27], v8 offset:10240
    v_mfma_f32_16x16x32_bf16 v[36:39], a[36:39], a[52:55], v[36:39]
    ds_read_b64_tr_b16 a[28:29], v9 offset:8192
    ds_read_b64_tr_b16 a[30:31], v9 offset:10240
    v_mfma_f32_16x16x32_bf16 v[28:31], a[36:39], a[48:51], v[28:31]
    ds_read_b64_tr_b16 a[4:5], v3 offset:8192
    ds_read_b64_tr_b16 a[6:7], v3 offset:10240
    v_mfma_f32_16x16x32_bf16 v[56:59], a[40:43], a[48:51], v[56:59]
    ds_read_b64_tr_b16 a[8:9], v4 offset:8192
    ds_read_b64_tr_b16 a[10:11], v4 offset:10240
    v_mfma_f32_16x16x32_bf16 v[64:67], a[40:43], a[52:55], v[64:67]
    ds_read_b64_tr_b16 a[12:13], v5 offset:8192
    ds_read_b64_tr_b16 a[14:15], v5 offset:10240
    v_mfma_f32_16x16x32_bf16 v[72:75], a[40:43], a[56:59], v[72:75]
    v_mfma_f32_16x16x32_bf16 v[80:83], a[40:43], a[60:63], v[80:83]
    v_mfma_f32_16x16x32_bf16 v[84:87], a[44:47], a[60:63], v[84:87]
    v_mfma_f32_16x16x32_bf16 v[76:79], a[44:47], a[56:59], v[76:79]
    v_mfma_f32_16x16x32_bf16 v[68:71], a[44:47], a[52:55], v[68:71]
    v_mfma_f32_16x16x32_bf16 v[60:63], a[44:47], a[48:51], v[60:63]
    s_cmp_lg_u32 s72, 2
    s_cbranch_scc1 Lres11
    v_mfma_f32_16x16x32_bf16 v[136:139], a[48:51], v[176:179], 0
    v_mfma_f32_16x16x32_bf16 v[140:143], a[52:55], v[176:179], 0
    v_mfma_f32_16x16x32_bf16 v[144:147], a[56:59], v[176:179], 0
    v_mfma_f32_16x16x32_bf16 v[148:151], a[60:63], v[176:179], 0
Lres11:
    s_waitcnt lgkmcnt(6)
    v_mfma_f32_16x16x32_bf16 v[24:27], a[0:3], a[16:19], v[24:27]
    s_barrier
    v_mfma_f32_16x16x32_bf16 v[32:35], a[0:3], a[20:23], v[32:35]
    ds_read_b64_tr_b16 a[32:33], v2 offset:12288
    v_mfma_f32_16x16x32_bf16 v[40:43], a[0:3], a[24:27], v[40:43]
    ds_read_b64_tr_b16 a[34:35], v2 offset:14336
    v_mfma_f32_16x16x32_bf16 v[48:51], a[0:3], a[28:31], v[48:51]
    ds_read_b64_tr_b16 a[48:49], v6 offset:12288
    ds_read_b64_tr_b16 a[50:51], v6 offset:14336
    s_waitcnt lgkmcnt(4)
    v_mfma_f32_16x16x32_bf16 v[52:55], a[4:7], a[28:31], v[52:55]
    ds_read_b64_tr_b16 a[52:53], v7 offset:12288
    v_mfma_f32_16x16x32_bf16 v[44:47], a[4:7], a[24:27], v[44:47]
    ds_read_b64_tr_b16 a[54:55], v7 offset:14336
    v_mfma_f32_16x16x32_bf16 v[36:39], a[4:7], a[20:23], v[36:39]
    ds_read_b64_tr_b16 a[56:57], v8 offset:12288
    ds_read_b64_tr_b16 a[58:59], v8 offset:14336
    v_mfma_f32_16x16x32_bf16 v[28:31], a[4:7], a[16:19], v[28:31]
    ds_read_b64_tr_b16 a[60:61], v9 offset:12288
    v_mfma_f32_16x16x32_bf16 v[56:59], a[8:11], a[16:19], v[56:59]
    ds_read_b64_tr_b16 a[62:63], v9 offset:14336
    v_mfma_f32_16x16x32_bf16 v[64:67], a[8:11], a[20:23], v[64:67]
    ds_read_b64_tr_b16 a[36:37], v3 offset:12288
    ds_read_b64_tr_b16 a[38:39], v3 offset:14336
    v_mfma_f32_16x16x32_bf16 v[72:75], a[8:11], a[24:27], v[72:75]
    v_mfma_f32_16x16x32_bf16 v[80:83], a[8:11], a[28:31], v[80:83]
    v_mfma_f32_16x16x32_bf16 v[84:87], a[12:15], a[28:31], v[84:87]
    v_mfma_f32_16x16x32_bf16 v[76:79], a[12:15], a[24:27], v[76:79]
    v_mfma_f32_16x16x32_bf16 v[68:71], a[12:15], a[20:23], v[68:71]
    v_mfma_f32_16x16x32_bf16 v[60:63], a[12:15], a[16:19], v[60:63]
    s_cmp_lg_u32 s72, 3
    s_cbranch_scc1 Lres12
    v_mfma_f32_16x16x32_bf16 v[88:91], a[16:19], v[176:179], 0
    v_mfma_f32_16x16x32_bf16 v[92:95], a[20:23], v[176:179], 0
    v_mfma_f32_16x16x32_bf16 v[96:99], a[24:27], v[176:179], 0
    v_mfma_f32_16x16x32_bf16 v[100:103], a[28:31], v[176:179], 0
Lres12:
    s_waitcnt lgkmcnt(8)
    v_mfma_f32_16x16x32_bf16 v[24:27], a[32:35], a[48:51], v[24:27]
    s_barrier
    s_waitcnt lgkmcnt(6)
    v_mfma_f32_16x16x32_bf16 v[32:35], a[32:35], a[52:55], v[32:35]
    ds_read_b64_tr_b16 a[0:1], v2 offset:16384
    ds_read_b64_tr_b16 a[2:3], v2 offset:18432
    s_waitcnt lgkmcnt(4)
    v_mfma_f32_16x16x32_bf16 v[40:43], a[32:35], a[56:59], v[40:43]
    ds_read_b64_tr_b16 a[16:17], v6 offset:16384
    ds_read_b64_tr_b16 a[18:19], v6 offset:18432
    v_mfma_f32_16x16x32_bf16 v[48:51], a[32:35], a[60:63], v[48:51]
    ds_read_b64_tr_b16 a[20:21], v7 offset:16384
    ds_read_b64_tr_b16 a[22:23], v7 offset:18432
    s_waitcnt lgkmcnt(6)
    v_mfma_f32_16x16x32_bf16 v[52:55], a[36:39], a[60:63], v[52:55]
    ds_read_b64_tr_b16 a[24:25], v8 offset:16384
    ds_read_b64_tr_b16 a[26:27], v8 offset:18432
    v_mfma_f32_16x16x32_bf16 v[44:47], a[36:39], a[56:59], v[44:47]
    ds_read_b64_tr_b16 a[28:29], v9 offset:16384
    ds_read_b64_tr_b16 a[30:31], v9 offset:18432
    v_mfma_f32_16x16x32_bf16 v[36:39], a[36:39], a[52:55], v[36:39]
    ds_read_b64_tr_b16 a[4:5], v3 offset:16384
    ds_read_b64_tr_b16 a[6:7], v3 offset:18432
    v_mfma_f32_16x16x32_bf16 v[28:31], a[36:39], a[48:51], v[28:31]
    s_cmp_lg_u32 s72, 3
    s_cbranch_scc1 Lres13
    v_mfma_f32_16x16x32_bf16 v[104:107], a[48:51], v[176:179], 0
    v_mfma_f32_16x16x32_bf16 v[108:111], a[52:55], v[176:179], 0
    v_mfma_f32_16x16x32_bf16 v[112:115], a[56:59], v[176:179], 0
    v_mfma_f32_16x16x32_bf16 v[116:119], a[60:63], v[176:179], 0
Lres13:
    s_waitcnt lgkmcnt(8)
    v_mfma_f32_16x16x32_bf16 v[24:27], a[0:3], a[16:19], v[24:27]
    ds_read_b64_tr_b16 a[32:33], v2 offset:20480
    s_waitcnt lgkmcnt(7)
    v_mfma_f32_16x16x32_bf16 v[32:35], a[0:3], a[20:23], v[32:35]
    ds_read_b64_tr_b16 a[34:35], v2 offset:22528
    ds_read_b64_tr_b16 a[40:41], v6 offset:20480
    s_waitcnt lgkmcnt(5)
    v_mfma_f32_16x16x32_bf16 v[40:43], a[0:3], a[24:27], v[40:43]
    ds_read_b64_tr_b16 a[42:43], v6 offset:22528
    ds_read_b64_tr_b16 a[44:45], v7 offset:20480
    v_mfma_f32_16x16x32_bf16 v[48:51], a[0:3], a[28:31], v[48:51]
    ds_read_b64_tr_b16 a[46:47], v7 offset:22528
    s_waitcnt lgkmcnt(6)
    v_mfma_f32_16x16x32_bf16 v[52:55], a[4:7], a[28:31], v[52:55]
    ds_read_b64_tr_b16 a[8:9], v8 offset:20480
    ds_read_b64_tr_b16 a[10:11], v8 offset:22528
    v_mfma_f32_16x16x32_bf16 v[44:47], a[4:7], a[24:27], v[44:47]
    ds_read_b64_tr_b16 a[12:13], v9 offset:20480
    ds_read_b64_tr_b16 a[14:15], v9 offset:22528
    v_mfma_f32_16x16x32_bf16 v[36:39], a[4:7], a[20:23], v[36:39]
    ds_read_b64_tr_b16 a[36:37], v3 offset:20480
    ds_read_b64_tr_b16 a[38:39], v3 offset:22528
    v_mfma_f32_16x16x32_bf16 v[28:31], a[4:7], a[16:19], v[28:31]
    s_cmp_lg_u32 s72, 3
    s_cbranch_scc1 Lres14
    v_mfma_f32_16x16x32_bf16 v[120:123], a[16:19], v[176:179], 0
    v_mfma_f32_16x16x32_bf16 v[124:127], a[20:23], v[176:179], 0
    v_mfma_f32_16x16x32_bf16 v[128:131], a[24:27], v[176:179], 0
    v_mfma_f32_16x16x32_bf16 v[132:135], a[28:31], v[176:179], 0
Lres14:
    s_waitcnt lgkmcnt(8)
    v_mfma_f32_16x16x32_bf16 v[24:27], a[32:35], a[40:43], v[24:27]
    ds_read_b64_tr_b16 v[184:185], v4 offset:12288
    s_waitcnt lgkmcnt(7)
    v_mfma_f32_16x16x32_bf16 v[32:35], a[32:35], a[44:47], v[32:35]
    ds_read_b64_tr_b16 v[186:187], v4 offset:14336
    s_waitcnt lgkmcnt(4)
    v_mfma_f32_16x16x32_bf16 v[40:43], a[32:35], a[8:11], v[40:43]
    ds_read_b64_tr_b16 v[188:189], v5 offset:12288
    v_mfma_f32_16x16x32_bf16 v[48:51], a[32:35], a[12:15], v[48:51]
    ds_read_b64_tr_b16 v[190:191], v5 offset:14336
    s_waitcnt lgkmcnt(4)
    v_mfma_f32_16x16x32_bf16 v[52:55], a[36:39], a[12:15], v[52:55]
    ds_read_b64_tr_b16 a[0:1], v4 offset:16384
    v_mfma_f32_16x16x32_bf16 v[44:47], a[36:39], a[8:11], v[44:47]
    ds_read_b64_tr_b16 a[2:3], v4 offset:18432
    v_mfma_f32_16x16x32_bf16 v[36:39], a[36:39], a[44:47], v[36:39]
    ds_read_b64_tr_b16 a[4:5], v5 offset:16384
    ds_read_b64_tr_b16 a[6:7], v5 offset:18432
    v_mfma_f32_16x16x32_bf16 v[28:31], a[36:39], a[40:43], v[28:31]
    s_cmp_lg_u32 s72, 3
    s_cbranch_scc1 Lres15
    v_mfma_f32_16x16x32_bf16 v[136:139], a[40:43], v[176:179], 0
    v_mfma_f32_16x16x32_bf16 v[140:143], a[44:47], v[176:179], 0
    v_mfma_f32_16x16x32_bf16 v[144:147], a[8:11], v[176:179], 0
    v_mfma_f32_16x16x32_bf16 v[148:151], a[12:15], v[176:179], 0
Lres15:
    ds_read_b64_tr_b16 a[32:33], v4 offset:20480
    ds_read_b64_tr_b16 a[34:35], v4 offset:22528
    ds_read_b64_tr_b16 a[36:37], v5 offset:20480
    ds_read_b64_tr_b16 a[38:39], v5 offset:22528
    s_nop 3
.p2align 3
    v_pk_fma_f32 v[24:25], v[24:25], s[52:53], v[152:153]
    v_pk_fma_f32 v[26:27], v[26:27], s[52:53], v[154:155]
    v_pk_fma_f32 v[28:29], v[28:29], s[52:53], v[156:157]
    v_pk_fma_f32 v[30:31], v[30:31], s[52:53], v[158:159]
    v_exp_f32 v168, v24
    v_exp_f32 v169, v25
    v_exp_f32 v170, v26
    v_exp_f32 v171, v27
    v_exp_f32 v172, v28
    v_exp_f32 v173, v29
    v_exp_f32 v174, v30
    v_exp_f32 v175, v31
    v_pk_fma_f32 v[168:169], v[168:169], s[54:55], s[54:55]
    v_pk_fma_f32 v[170:171], v[170:171], s[54:55], s[54:55]
    v_pk_fma_f32 v[172:173], v[172:173], s[54:55], s[54:55]
    v_pk_fma_f32 v[174:175], v[174:175], s[54:55], s[54:55]
    v_rcp_f32 v168, v168
    v_rcp_f32 v169, v169
    v_rcp_f32 v170, v170
    v_rcp_f32 v171, v171
    v_rcp_f32 v172, v172
    v_rcp_f32 v173, v173
    v_rcp_f32 v174, v174
    v_rcp_f32 v175, v175
    v_pk_mul_f32 v[168:169], v[24:25], v[168:169]
    v_pk_mul_f32 v[170:171], v[26:27], v[170:171]
    v_pk_mul_f32 v[172:173], v[28:29], v[172:173]
    v_pk_mul_f32 v[174:175], v[30:31], v[174:175]
    v_cvt_pk_bf16_f32 v24, v168, v169
    v_cvt_pk_bf16_f32 v25, v170, v171
    v_cvt_pk_bf16_f32 v26, v172, v173
    v_cvt_pk_bf16_f32 v27, v174, v175
    buffer_store_dwordx4 v[24:27], v15, s[60:63], s64 offen offset:0 sc1
.p2align 3
    v_pk_fma_f32 v[32:33], v[32:33], s[52:53], v[152:153]
    v_pk_fma_f32 v[34:35], v[34:35], s[52:53], v[154:155]
    v_pk_fma_f32 v[36:37], v[36:37], s[52:53], v[156:157]
    v_pk_fma_f32 v[38:39], v[38:39], s[52:53], v[158:159]
    v_exp_f32 v176, v32
    v_exp_f32 v177, v33
    v_exp_f32 v178, v34
    v_exp_f32 v179, v35
    v_exp_f32 v180, v36
    v_exp_f32 v181, v37
    v_exp_f32 v182, v38
    v_exp_f32 v183, v39
    v_pk_fma_f32 v[176:177], v[176:177], s[54:55], s[54:55]
    v_pk_fma_f32 v[178:179], v[178:179], s[54:55], s[54:55]
    v_pk_fma_f32 v[180:181], v[180:181], s[54:55], s[54:55]
    v_pk_fma_f32 v[182:183], v[182:183], s[54:55], s[54:55]
    v_rcp_f32 v176, v176
    v_rcp_f32 v177, v177
    v_rcp_f32 v178, v178
    v_rcp_f32 v179, v179
    v_rcp_f32 v180, v180
    v_rcp_f32 v181, v181
    v_rcp_f32 v182, v182
    v_rcp_f32 v183, v183
    v_pk_mul_f32 v[176:177], v[32:33], v[176:177]
    v_pk_mul_f32 v[178:179], v[34:35], v[178:179]
    v_pk_mul_f32 v[180:181], v[36:37], v[180:181]
    v_pk_mul_f32 v[182:183], v[38:39], v[182:183]
    v_cvt_pk_bf16_f32 v32, v176, v177
    v_cvt_pk_bf16_f32 v33, v178, v179
    v_cvt_pk_bf16_f32 v34, v180, v181
    v_cvt_pk_bf16_f32 v35, v182, v183
    buffer_store_dwordx4 v[32:35], v15, s[60:63], s64 offen offset:1024 sc1
.p2align 3
    v_pk_fma_f32 v[40:41], v[40:41], s[52:53], v[152:153]
    v_pk_fma_f32 v[42:43], v[42:43], s[52:53], v[154:155]
    v_pk_fma_f32 v[44:45], v[44:45], s[52:53], v[156:157]
    v_pk_fma_f32 v[46:47], v[46:47], s[52:53], v[158:159]
    v_exp_f32 v168, v40
    v_exp_f32 v169, v41
    v_exp_f32 v170, v42
    v_exp_f32 v171, v43
    v_exp_f32 v172, v44
    v_exp_f32 v173, v45
    v_exp_f32 v174, v46
    v_exp_f32 v175, v47
    v_pk_fma_f32 v[168:169], v[168:169], s[54:55], s[54:55]
    v_pk_fma_f32 v[170:171], v[170:171], s[54:55], s[54:55]
    v_pk_fma_f32 v[172:173], v[172:173], s[54:55], s[54:55]
    v_pk_fma_f32 v[174:175], v[174:175], s[54:55], s[54:55]
    v_rcp_f32 v168, v168
    v_rcp_f32 v169, v169
    v_rcp_f32 v170, v170
    v_rcp_f32 v171, v171
    v_rcp_f32 v172, v172
    v_rcp_f32 v173, v173
    v_rcp_f32 v174, v174
    v_rcp_f32 v175, v175
    v_pk_mul_f32 v[168:169], v[40:41], v[168:169]
    v_pk_mul_f32 v[170:171], v[42:43], v[170:171]
    v_pk_mul_f32 v[172:173], v[44:45], v[172:173]
    v_pk_mul_f32 v[174:175], v[46:47], v[174:175]
    v_cvt_pk_bf16_f32 v40, v168, v169
    v_cvt_pk_bf16_f32 v41, v170, v171
    v_cvt_pk_bf16_f32 v42, v172, v173
    v_cvt_pk_bf16_f32 v43, v174, v175
    buffer_store_dwordx4 v[40:43], v15, s[60:63], s64 offen offset:2048 sc1
.p2align 3
    v_pk_fma_f32 v[48:49], v[48:49], s[52:53], v[152:153]
    v_pk_fma_f32 v[50:51], v[50:51], s[52:53], v[154:155]
    v_pk_fma_f32 v[52:53], v[52:53], s[52:53], v[156:157]
    v_pk_fma_f32 v[54:55], v[54:55], s[52:53], v[158:159]
    v_exp_f32 v176, v48
    v_exp_f32 v177, v49
    v_exp_f32 v178, v50
    v_exp_f32 v179, v51
    v_exp_f32 v180, v52
    v_exp_f32 v181, v53
    v_exp_f32 v182, v54
    v_exp_f32 v183, v55
    v_pk_fma_f32 v[176:177], v[176:177], s[54:55], s[54:55]
    v_pk_fma_f32 v[178:179], v[178:179], s[54:55], s[54:55]
    v_pk_fma_f32 v[180:181], v[180:181], s[54:55], s[54:55]
    v_pk_fma_f32 v[182:183], v[182:183], s[54:55], s[54:55]
    v_rcp_f32 v176, v176
    v_rcp_f32 v177, v177
    v_rcp_f32 v178, v178
    v_rcp_f32 v179, v179
    v_rcp_f32 v180, v180
    v_rcp_f32 v181, v181
    v_rcp_f32 v182, v182
    v_rcp_f32 v183, v183
    v_pk_mul_f32 v[176:177], v[48:49], v[176:177]
    v_pk_mul_f32 v[178:179], v[50:51], v[178:179]
    v_pk_mul_f32 v[180:181], v[52:53], v[180:181]
    v_pk_mul_f32 v[182:183], v[54:55], v[182:183]
    v_cvt_pk_bf16_f32 v48, v176, v177
    v_cvt_pk_bf16_f32 v49, v178, v179
    v_cvt_pk_bf16_f32 v50, v180, v181
    v_cvt_pk_bf16_f32 v51, v182, v183
    buffer_store_dwordx4 v[48:51], v15, s[60:63], s64 offen offset:3072 sc1
    s_waitcnt lgkmcnt(0)
    v_mfma_f32_16x16x32_bf16 v[56:59], v[184:187], a[48:51], v[56:59]
    ds_write_b128 v11, v[24:27] offset:24576
    v_mfma_f32_16x16x32_bf16 v[64:67], v[184:187], a[52:55], v[64:67]
    v_mfma_f32_16x16x32_bf16 v[72:75], v[184:187], a[56:59], v[72:75]
    v_mfma_f32_16x16x32_bf16 v[80:83], v[184:187], a[60:63], v[80:83]
    v_mfma_f32_16x16x32_bf16 v[84:87], v[188:191], a[60:63], v[84:87]
    v_mfma_f32_16x16x32_bf16 v[76:79], v[188:191], a[56:59], v[76:79]
    v_mfma_f32_16x16x32_bf16 v[68:71], v[188:191], a[52:55], v[68:71]
    ds_write_b128 v11, v[32:35] offset:25600
    v_mfma_f32_16x16x32_bf16 v[60:63], v[188:191], a[48:51], v[60:63]
    v_mfma_f32_16x16x32_bf16 v[56:59], a[0:3], a[16:19], v[56:59]
    v_mfma_f32_16x16x32_bf16 v[64:67], a[0:3], a[20:23], v[64:67]
    v_mfma_f32_16x16x32_bf16 v[72:75], a[0:3], a[24:27], v[72:75]
    v_mfma_f32_16x16x32_bf16 v[80:83], a[0:3], a[28:31], v[80:83]
    v_mfma_f32_16x16x32_bf16 v[84:87], a[4:7], a[28:31], v[84:87]
    ds_write_b128 v11, v[40:43] offset:26624
    v_mfma_f32_16x16x32_bf16 v[76:79], a[4:7], a[24:27], v[76:79]
    v_mfma_f32_16x16x32_bf16 v[68:71], a[4:7], a[20:23], v[68:71]
    v_mfma_f32_16x16x32_bf16 v[60:63], a[4:7], a[16:19], v[60:63]
    v_mfma_f32_16x16x32_bf16 v[56:59], a[32:35], a[40:43], v[56:59]
    v_mfma_f32_16x16x32_bf16 v[64:67], a[32:35], a[44:47], v[64:67]
    v_mfma_f32_16x16x32_bf16 v[72:75], a[32:35], a[8:11], v[72:75]
    ds_write_b128 v11, v[48:51] offset:27648
    v_mfma_f32_16x16x32_bf16 v[80:83], a[32:35], a[12:15], v[80:83]
    v_mfma_f32_16x16x32_bf16 v[84:87], a[36:39], a[12:15], v[84:87]
    v_mfma_f32_16x16x32_bf16 v[76:79], a[36:39], a[8:11], v[76:79]
    v_mfma_f32_16x16x32_bf16 v[68:71], a[36:39], a[44:47], v[68:71]
    v_mfma_f32_16x16x32_bf16 v[60:63], a[36:39], a[40:43], v[60:63]
    s_nop 7
.p2align 3
    v_pk_fma_f32 v[56:57], v[56:57], s[52:53], v[160:161]
    v_pk_fma_f32 v[58:59], v[58:59], s[52:53], v[162:163]
    v_pk_fma_f32 v[60:61], v[60:61], s[52:53], v[164:165]
    v_pk_fma_f32 v[62:63], v[62:63], s[52:53], v[166:167]
    v_exp_f32 v168, v56
    v_exp_f32 v169, v57
    v_exp_f32 v170, v58
    v_exp_f32 v171, v59
    v_exp_f32 v172, v60
    v_exp_f32 v173, v61
    v_exp_f32 v174, v62
    v_exp_f32 v175, v63
    v_pk_fma_f32 v[168:169], v[168:169], s[54:55], s[54:55]
    v_pk_fma_f32 v[170:171], v[170:171], s[54:55], s[54:55]
    v_pk_fma_f32 v[172:173], v[172:173], s[54:55], s[54:55]
    v_pk_fma_f32 v[174:175], v[174:175], s[54:55], s[54:55]
    v_rcp_f32 v168, v168
    v_rcp_f32 v169, v169
    v_rcp_f32 v170, v170
    v_rcp_f32 v171, v171
    v_rcp_f32 v172, v172
    v_rcp_f32 v173, v173
    v_rcp_f32 v174, v174
    v_rcp_f32 v175, v175
    v_pk_mul_f32 v[168:169], v[56:57], v[168:169]
    v_pk_mul_f32 v[170:171], v[58:59], v[170:171]
    v_pk_mul_f32 v[172:173], v[60:61], v[172:173]
    v_pk_mul_f32 v[174:175], v[62:63], v[174:175]
    v_cvt_pk_bf16_f32 v56, v168, v169
    v_cvt_pk_bf16_f32 v57, v170, v171
    v_cvt_pk_bf16_f32 v58, v172, v173
    v_cvt_pk_bf16_f32 v59, v174, v175
.p2align 3
    v_pk_fma_f32 v[64:65], v[64:65], s[52:53], v[160:161]
    v_pk_fma_f32 v[66:67], v[66:67], s[52:53], v[162:163]
    v_pk_fma_f32 v[68:69], v[68:69], s[52:53], v[164:165]
    v_pk_fma_f32 v[70:71], v[70:71], s[52:53], v[166:167]
    v_exp_f32 v176, v64
    v_exp_f32 v177, v65
    v_exp_f32 v178, v66
    v_exp_f32 v179, v67
    v_exp_f32 v180, v68
    v_exp_f32 v181, v69
    v_exp_f32 v182, v70
    v_exp_f32 v183, v71
    v_pk_fma_f32 v[176:177], v[176:177], s[54:55], s[54:55]
    v_pk_fma_f32 v[178:179], v[178:179], s[54:55], s[54:55]
    v_pk_fma_f32 v[180:181], v[180:181], s[54:55], s[54:55]
    v_pk_fma_f32 v[182:183], v[182:183], s[54:55], s[54:55]
    v_rcp_f32 v176, v176
    v_rcp_f32 v177, v177
    v_rcp_f32 v178, v178
    v_rcp_f32 v179, v179
    v_rcp_f32 v180, v180
    v_rcp_f32 v181, v181
    v_rcp_f32 v182, v182
    v_rcp_f32 v183, v183
    s_waitcnt vmcnt(0)
    s_mov_b64 exec, 1
    buffer_store_dword v16, off, s[68:71], s65
    s_mov_b64 exec, -1
    s_add_u32 s64, s64, 4096
    buffer_store_dwordx4 v[56:59], v15, s[60:63], s64 offen offset:0 sc1
.p2align 3
    v_pk_mul_f32 v[176:177], v[64:65], v[176:177]
    v_pk_mul_f32 v[178:179], v[66:67], v[178:179]
    v_pk_mul_f32 v[180:181], v[68:69], v[180:181]
    v_pk_mul_f32 v[182:183], v[70:71], v[182:183]
    v_cvt_pk_bf16_f32 v64, v176, v177
    v_cvt_pk_bf16_f32 v65, v178, v179
    v_cvt_pk_bf16_f32 v66, v180, v181
    v_cvt_pk_bf16_f32 v67, v182, v183
    buffer_store_dwordx4 v[64:67], v15, s[60:63], s64 offen offset:1024 sc1
.p2align 3
    v_pk_fma_f32 v[72:73], v[72:73], s[52:53], v[160:161]
    v_pk_fma_f32 v[74:75], v[74:75], s[52:53], v[162:163]
    v_pk_fma_f32 v[76:77], v[76:77], s[52:53], v[164:165]
    v_pk_fma_f32 v[78:79], v[78:79], s[52:53], v[166:167]
    v_exp_f32 v168, v72
    v_exp_f32 v169, v73
    v_exp_f32 v170, v74
    v_exp_f32 v171, v75
    v_exp_f32 v172, v76
    v_exp_f32 v173, v77
    v_exp_f32 v174, v78
    v_exp_f32 v175, v79
    v_pk_fma_f32 v[168:169], v[168:169], s[54:55], s[54:55]
    v_pk_fma_f32 v[170:171], v[170:171], s[54:55], s[54:55]
    v_pk_fma_f32 v[172:173], v[172:173], s[54:55], s[54:55]
    v_pk_fma_f32 v[174:175], v[174:175], s[54:55], s[54:55]
    v_rcp_f32 v168, v168
    v_rcp_f32 v169, v169
    v_rcp_f32 v170, v170
    v_rcp_f32 v171, v171
    v_rcp_f32 v172, v172
    v_rcp_f32 v173, v173
    v_rcp_f32 v174, v174
    v_rcp_f32 v175, v175
    v_pk_mul_f32 v[168:169], v[72:73], v[168:169]
    v_pk_mul_f32 v[170:171], v[74:75], v[170:171]
    v_pk_mul_f32 v[172:173], v[76:77], v[172:173]
    v_pk_mul_f32 v[174:175], v[78:79], v[174:175]
    v_cvt_pk_bf16_f32 v72, v168, v169
    v_cvt_pk_bf16_f32 v73, v170, v171
    v_cvt_pk_bf16_f32 v74, v172, v173
    v_cvt_pk_bf16_f32 v75, v174, v175
    buffer_store_dwordx4 v[72:75], v15, s[60:63], s64 offen offset:2048 sc1
.p2align 3
    v_pk_fma_f32 v[80:81], v[80:81], s[52:53], v[160:161]
    v_pk_fma_f32 v[82:83], v[82:83], s[52:53], v[162:163]
    v_pk_fma_f32 v[84:85], v[84:85], s[52:53], v[164:165]
    v_pk_fma_f32 v[86:87], v[86:87], s[52:53], v[166:167]
    v_exp_f32 v176, v80
    v_exp_f32 v177, v81
    v_exp_f32 v178, v82
    v_exp_f32 v179, v83
    v_exp_f32 v180, v84
    v_exp_f32 v181, v85
    v_exp_f32 v182, v86
    v_exp_f32 v183, v87
    v_pk_fma_f32 v[176:177], v[176:177], s[54:55], s[54:55]
    v_pk_fma_f32 v[178:179], v[178:179], s[54:55], s[54:55]
    v_pk_fma_f32 v[180:181], v[180:181], s[54:55], s[54:55]
    v_pk_fma_f32 v[182:183], v[182:183], s[54:55], s[54:55]
    v_rcp_f32 v176, v176
    v_rcp_f32 v177, v177
    v_rcp_f32 v178, v178
    v_rcp_f32 v179, v179
    v_rcp_f32 v180, v180
    v_rcp_f32 v181, v181
    v_rcp_f32 v182, v182
    v_rcp_f32 v183, v183
    v_pk_mul_f32 v[176:177], v[80:81], v[176:177]
    v_pk_mul_f32 v[178:179], v[82:83], v[178:179]
    v_pk_mul_f32 v[180:181], v[84:85], v[180:181]
    v_pk_mul_f32 v[182:183], v[86:87], v[182:183]
    v_cvt_pk_bf16_f32 v80, v176, v177
    v_cvt_pk_bf16_f32 v81, v178, v179
    v_cvt_pk_bf16_f32 v82, v180, v181
    v_cvt_pk_bf16_f32 v83, v182, v183
    buffer_store_dwordx4 v[80:83], v15, s[60:63], s64 offen offset:3072 sc1
    ds_write_b128 v11, v[56:59] offset:28672
    ds_write_b128 v11, v[64:67] offset:29696
    ds_write_b128 v11, v[72:75] offset:30720
    ds_write_b128 v11, v[80:83] offset:31744
    s_waitcnt lgkmcnt(0)
    s_barrier
    ds_read_b64_tr_b16 a[0:1], v2 offset:24576
    ds_read_b64_tr_b16 a[2:3], v2 offset:26624
    ds_read_b128 a[16:19], v10 offset:24576
    ds_read_b128 a[20:23], v10 offset:25600
    ds_read_b128 a[24:27], v10 offset:26624
    ds_read_b128 a[28:31], v10 offset:27648
    ds_read_b64_tr_b16 a[4:5], v3 offset:24576
    ds_read_b64_tr_b16 a[6:7], v3 offset:26624
    ds_read_b64_tr_b16 a[8:9], v4 offset:24576
    ds_read_b64_tr_b16 a[10:11], v4 offset:26624
    ds_read_b64_tr_b16 a[12:13], v5 offset:24576
    ds_read_b64_tr_b16 a[14:15], v5 offset:26624
    s_waitcnt lgkmcnt(9)
    v_mfma_f32_16x16x32_bf16 v[88:91], a[16:19], a[0:3], v[88:91]
    v_add_u32 v16, 0x50, v16
    s_waitcnt lgkmcnt(8)
    v_mfma_f32_16x16x32_bf16 v[92:95], a[20:23], a[0:3], v[92:95]
    ds_read_b64_tr_b16 a[32:33], v2 offset:28672
    s_waitcnt lgkmcnt(8)
    v_mfma_f32_16x16x32_bf16 v[96:99], a[24:27], a[0:3], v[96:99]
    ds_read_b64_tr_b16 a[34:35], v2 offset:30720
    s_waitcnt lgkmcnt(8)
    v_mfma_f32_16x16x32_bf16 v[100:103], a[28:31], a[0:3], v[100:103]
    ds_read_b128 a[48:51], v10 offset:28672
    s_waitcnt lgkmcnt(3)
    v_mfma_f32_16x16x32_bf16 v[116:119], a[28:31], a[4:7], v[116:119]
    v_mfma_f32_16x16x32_bf16 v[112:115], a[24:27], a[4:7], v[112:115]
    ds_read_b128 a[52:55], v10 offset:29696
    v_mfma_f32_16x16x32_bf16 v[108:111], a[20:23], a[4:7], v[108:111]
    ds_read_b128 a[56:59], v10 offset:30720
    v_mfma_f32_16x16x32_bf16 v[104:107], a[16:19], a[4:7], v[104:107]
    ds_read_b128 a[60:63], v10 offset:31744
    v_mfma_f32_16x16x32_bf16 v[120:123], a[16:19], a[8:11], v[120:123]
    v_mfma_f32_16x16x32_bf16 v[124:127], a[20:23], a[8:11], v[124:127]
    ds_read_b64_tr_b16 a[36:37], v3 offset:28672
    v_mfma_f32_16x16x32_bf16 v[128:131], a[24:27], a[8:11], v[128:131]
    ds_read_b64_tr_b16 a[38:39], v3 offset:30720
    v_mfma_f32_16x16x32_bf16 v[132:135], a[28:31], a[8:11], v[132:135]
    ds_read_b64_tr_b16 a[40:41], v4 offset:28672
    v_mfma_f32_16x16x32_bf16 v[148:151], a[28:31], a[12:15], v[148:151]
    v_mfma_f32_16x16x32_bf16 v[144:147], a[24:27], a[12:15], v[144:147]
    ds_read_b64_tr_b16 a[42:43], v4 offset:30720
    v_mfma_f32_16x16x32_bf16 v[140:143], a[20:23], a[12:15], v[140:143]
    ds_read_b64_tr_b16 a[44:45], v5 offset:28672
    v_mfma_f32_16x16x32_bf16 v[136:139], a[16:19], a[12:15], v[136:139]
    ds_read_b64_tr_b16 a[46:47], v5 offset:30720
    s_waitcnt lgkmcnt(6)
    v_mfma_f32_16x16x32_bf16 v[88:91], a[48:51], a[32:35], v[88:91]
    v_mfma_f32_16x16x32_bf16 v[92:95], a[52:55], a[32:35], v[92:95]
    ds_read_b64_tr_b16 a[0:1], v2 offset:32768
    v_mfma_f32_16x16x32_bf16 v[96:99], a[56:59], a[32:35], v[96:99]
    ds_read_b64_tr_b16 a[2:3], v2 offset:34816
    v_mfma_f32_16x16x32_bf16 v[100:103], a[60:63], a[32:35], v[100:103]
    ds_read_b128 a[16:19], v10 offset:32768
    s_waitcnt lgkmcnt(3)
    v_mfma_f32_16x16x32_bf16 v[116:119], a[60:63], a[36:39], v[116:119]
    s_waitcnt vmcnt(0)
    s_mov_b64 exec, 1
    buffer_store_dword v16, off, s[68:71], s65
    s_mov_b64 exec, -1
    v_mfma_f32_16x16x32_bf16 v[112:115], a[56:59], a[36:39], v[112:115]
    ds_read_b128 a[20:23], v10 offset:33792
    v_mfma_f32_16x16x32_bf16 v[108:111], a[52:55], a[36:39], v[108:111]
    ds_read_b128 a[24:27], v10 offset:34816
    v_mfma_f32_16x16x32_bf16 v[104:107], a[48:51], a[36:39], v[104:107]
    ds_read_b128 a[28:31], v10 offset:35840
    v_mfma_f32_16x16x32_bf16 v[120:123], a[48:51], a[40:43], v[120:123]
    v_mfma_f32_16x16x32_bf16 v[124:127], a[52:55], a[40:43], v[124:127]
    ds_read_b64_tr_b16 a[4:5], v3 offset:32768
    v_mfma_f32_16x16x32_bf16 v[128:131], a[56:59], a[40:43], v[128:131]
    ds_read_b64_tr_b16 a[6:7], v3 offset:34816
    v_mfma_f32_16x16x32_bf16 v[132:135], a[60:63], a[40:43], v[132:135]
    ds_read_b64_tr_b16 a[8:9], v4 offset:32768
    v_mfma_f32_16x16x32_bf16 v[148:151], a[60:63], a[44:47], v[148:151]
    v_mfma_f32_16x16x32_bf16 v[144:147], a[56:59], a[44:47], v[144:147]
Lpg2:
    s_cbranch_vccnz Lpr2
    s_nop 0
    ds_read_b64_tr_b16 a[10:11], v4 offset:34816
    v_mfma_f32_16x16x32_bf16 v[140:143], a[52:55], a[44:47], v[140:143]
    ds_read_b64_tr_b16 a[12:13], v5 offset:32768
    v_mfma_f32_16x16x32_bf16 v[136:139], a[48:51], a[44:47], v[136:139]
    ds_read_b64_tr_b16 a[14:15], v5 offset:34816
    s_waitcnt lgkmcnt(6)
    v_mfma_f32_16x16x32_bf16 v[88:91], a[16:19], a[0:3], v[88:91]
    v_mfma_f32_16x16x32_bf16 v[92:95], a[20:23], a[0:3], v[92:95]
    ds_read_b64_tr_b16 a[32:33], v2 offset:36864
    v_mfma_f32_16x16x32_bf16 v[96:99], a[24:27], a[0:3], v[96:99]
    ds_read_b64_tr_b16 a[34:35], v2 offset:38912
    v_mfma_f32_16x16x32_bf16 v[100:103], a[28:31], a[0:3], v[100:103]
    ds_read_b128 a[48:51], v10 offset:36864
    s_waitcnt lgkmcnt(3)
    v_mfma_f32_16x16x32_bf16 v[116:119], a[28:31], a[4:7], v[116:119]
    v_mfma_f32_16x16x32_bf16 v[112:115], a[24:27], a[4:7], v[112:115]
    ds_read_b128 a[52:55], v10 offset:37888
    v_mfma_f32_16x16x32_bf16 v[108:111], a[20:23], a[4:7], v[108:111]
    ds_read_b128 a[56:59], v10 offset:38912
    v_mfma_f32_16x16x32_bf16 v[104:107], a[16:19], a[4:7], v[104:107]
    ds_read_b128 a[60:63], v10 offset:39936
    v_mfma_f32_16x16x32_bf16 v[120:123], a[16:19], a[8:11], v[120:123]
    v_mfma_f32_16x16x32_bf16 v[124:127], a[20:23], a[8:11], v[124:127]
    ds_read_b64_tr_b16 a[36:37], v3 offset:36864
    v_mfma_f32_16x16x32_bf16 v[128:131], a[24:27], a[8:11], v[128:131]
    ds_read_b64_tr_b16 a[38:39], v3 offset:38912
    v_mfma_f32_16x16x32_bf16 v[132:135], a[28:31], a[8:11], v[132:135]
    ds_read_b64_tr_b16 a[40:41], v4 offset:36864
    v_mfma_f32_16x16x32_bf16 v[148:151], a[28:31], a[12:15], v[148:151]
    v_mfma_f32_16x16x32_bf16 v[144:147], a[24:27], a[12:15], v[144:147]
    ds_read_b64_tr_b16 a[42:43], v4 offset:38912
    v_mfma_f32_16x16x32_bf16 v[140:143], a[20:23], a[12:15], v[140:143]
    ds_read_b64_tr_b16 a[44:45], v5 offset:36864
    v_mfma_f32_16x16x32_bf16 v[136:139], a[16:19], a[12:15], v[136:139]
    ds_read_b64_tr_b16 a[46:47], v5 offset:38912
    s_waitcnt lgkmcnt(6)
    v_mfma_f32_16x16x32_bf16 v[88:91], a[48:51], a[32:35], v[88:91]
    s_barrier
    v_mfma_f32_16x16x32_bf16 v[92:95], a[52:55], a[32:35], v[92:95]
    v_mfma_f32_16x16x32_bf16 v[96:99], a[56:59], a[32:35], v[96:99]
    ds_read_b64_tr_b16 a[0:1], v2 offset:0
    v_mfma_f32_16x16x32_bf16 v[100:103], a[60:63], a[32:35], v[100:103]
    ds_read_b64_tr_b16 a[2:3], v2 offset:2048
    s_waitcnt lgkmcnt(2)
    v_mfma_f32_16x16x32_bf16 v[116:119], a[60:63], a[36:39], v[116:119]
    ds_read_b128 a[16:19], v10 offset:0
    v_mfma_f32_16x16x32_bf16 v[112:115], a[56:59], a[36:39], v[112:115]
    ds_read_b128 a[20:23], v10 offset:1024
    v_mfma_f32_16x16x32_bf16 v[108:111], a[52:55], a[36:39], v[108:111]
    v_mfma_f32_16x16x32_bf16 v[104:107], a[48:51], a[36:39], v[104:107]
    ds_read_b128 a[24:27], v10 offset:2048
    v_mfma_f32_16x16x32_bf16 v[120:123], a[48:51], a[40:43], v[120:123]
    ds_read_b128 a[28:31], v10 offset:3072
    v_mfma_f32_16x16x32_bf16 v[124:127], a[52:55], a[40:43], v[124:127]
    ds_read_b64_tr_b16 a[4:5], v3 offset:0
    v_mfma_f32_16x16x32_bf16 v[128:131], a[56:59], a[40:43], v[128:131]
    ds_read_b64_tr_b16 a[6:7], v3 offset:2048
    v_mfma_f32_16x16x32_bf16 v[132:135], a[60:63], a[40:43], v[132:135]
    v_mfma_f32_16x16x32_bf16 v[148:151], a[60:63], a[44:47], v[148:151]
    ds_read_b64_tr_b16 a[8:9], v4 offset:0
    v_mfma_f32_16x16x32_bf16 v[144:147], a[56:59], a[44:47], v[144:147]
    ds_read_b64_tr_b16 a[10:11], v4 offset:2048
    v_mfma_f32_16x16x32_bf16 v[140:143], a[52:55], a[44:47], v[140:143]
    ds_read_b64_tr_b16 a[12:13], v5 offset:0
    v_mfma_f32_16x16x32_bf16 v[136:139], a[48:51], a[44:47], v[136:139]
    ds_read_b64_tr_b16 a[14:15], v5 offset:2048
    s_waitcnt lgkmcnt(6)
    v_mfma_f32_16x16x32_bf16 v[88:91], a[16:19], a[0:3], v[88:91]
    s_barrier
    v_mfma_f32_16x16x32_bf16 v[92:95], a[20:23], a[0:3], v[92:95]
    v_mfma_f32_16x16x32_bf16 v[96:99], a[24:27], a[0:3], v[96:99]
    ds_read_b64_tr_b16 a[32:33], v2 offset:4096
    v_mfma_f32_16x16x32_bf16 v[100:103], a[28:31], a[0:3], v[100:103]
    ds_read_b64_tr_b16 a[34:35], v2 offset:6144
    s_waitcnt lgkmcnt(2)
    v_mfma_f32_16x16x32_bf16 v[116:119], a[28:31], a[4:7], v[116:119]
    ds_read_b128 a[48:51], v10 offset:4096
    v_mfma_f32_16x16x32_bf16 v[112:115], a[24:27], a[4:7], v[112:115]
    ds_read_b128 a[52:55], v10 offset:5120
    v_mfma_f32_16x16x32_bf16 v[108:111], a[20:23], a[4:7], v[108:111]
    v_mfma_f32_16x16x32_bf16 v[104:107], a[16:19], a[4:7], v[104:107]
    ds_read_b128 a[56:59], v10 offset:6144
    v_mfma_f32_16x16x32_bf16 v[120:123], a[16:19], a[8:11], v[120:123]
    ds_read_b128 a[60:63], v10 offset:7168
    v_mfma_f32_16x16x32_bf16 v[124:127], a[20:23], a[8:11], v[124:127]
    ds_read_b64_tr_b16 a[36:37], v3 offset:4096
    v_mfma_f32_16x16x32_bf16 v[128:131], a[24:27], a[8:11], v[128:131]
    ds_read_b64_tr_b16 a[38:39], v3 offset:6144
    v_mfma_f32_16x16x32_bf16 v[132:135], a[28:31], a[8:11], v[132:135]
    v_mfma_f32_16x16x32_bf16 v[148:151], a[28:31], a[12:15], v[148:151]
    ds_read_b64_tr_b16 a[40:41], v4 offset:4096
    v_mfma_f32_16x16x32_bf16 v[144:147], a[24:27], a[12:15], v[144:147]
    ds_read_b64_tr_b16 a[42:43], v4 offset:6144
    v_mfma_f32_16x16x32_bf16 v[140:143], a[20:23], a[12:15], v[140:143]
    ds_read_b64_tr_b16 a[44:45], v5 offset:4096
    v_mfma_f32_16x16x32_bf16 v[136:139], a[16:19], a[12:15], v[136:139]
    ds_read_b64_tr_b16 a[46:47], v5 offset:6144
    s_waitcnt lgkmcnt(6)
    v_mfma_f32_16x16x32_bf16 v[88:91], a[48:51], a[32:35], v[88:91]
    s_barrier
    v_mfma_f32_16x16x32_bf16 v[92:95], a[52:55], a[32:35], v[92:95]
    v_mfma_f32_16x16x32_bf16 v[96:99], a[56:59], a[32:35], v[96:99]
    ds_read_b64_tr_b16 a[0:1], v2 offset:8192
    v_mfma_f32_16x16x32_bf16 v[100:103], a[60:63], a[32:35], v[100:103]
    ds_read_b64_tr_b16 a[2:3], v2 offset:10240
    s_waitcnt lgkmcnt(2)
    v_mfma_f32_16x16x32_bf16 v[116:119], a[60:63], a[36:39], v[116:119]
    ds_read_b128 a[16:19], v10 offset:8192
    v_mfma_f32_16x16x32_bf16 v[112:115], a[56:59], a[36:39], v[112:115]
    ds_read_b128 a[20:23], v10 offset:9216
    v_mfma_f32_16x16x32_bf16 v[108:111], a[52:55], a[36:39], v[108:111]
    v_mfma_f32_16x16x32_bf16 v[104:107], a[48:51], a[36:39], v[104:107]
    ds_read_b128 a[24:27], v10 offset:10240
    v_mfma_f32_16x16x32_bf16 v[120:123], a[48:51], a[40:43], v[120:123]
    ds_read_b128 a[28:31], v10 offset:11264
    v_mfma_f32_16x16x32_bf16 v[124:127], a[52:55], a[40:43], v[124:127]
    ds_read_b64_tr_b16 a[4:5], v3 offset:8192
    v_mfma_f32_16x16x32_bf16 v[128:131], a[56:59], a[40:43], v[128:131]
    ds_read_b64_tr_b16 a[6:7], v3 offset:10240
    v_mfma_f32_16x16x32_bf16 v[132:135], a[60:63], a[40:43], v[132:135]
    v_mfma_f32_16x16x32_bf16 v[148:151], a[60:63], a[44:47], v[148:151]
    ds_read_b64_tr_b16 a[8:9], v4 offset:8192
    v_mfma_f32_16x16x32_bf16 v[144:147], a[56:59], a[44:47], v[144:147]
    ds_read_b64_tr_b16 a[10:11], v4 offset:10240
    v_mfma_f32_16x16x32_bf16 v[140:143], a[52:55], a[44:47], v[140:143]
    ds_read_b64_tr_b16 a[12:13], v5 offset:8192
    v_mfma_f32_16x16x32_bf16 v[136:139], a[48:51], a[44:47], v[136:139]
    ds_read_b64_tr_b16 a[14:15], v5 offset:10240
    s_waitcnt lgkmcnt(6)
    v_mfma_f32_16x16x32_bf16 v[88:91], a[16:19], a[0:3], v[88:91]
    v_mfma_f32_16x16x32_bf16 v[92:95], a[20:23], a[0:3], v[92:95]
    ds_read_b64_tr_b16 a[32:33], v2 offset:12288
    v_mfma_f32_16x16x32_bf16 v[96:99], a[24:27], a[0:3], v[96:99]
    ds_read_b64_tr_b16 a[34:35], v2 offset:14336
    v_mfma_f32_16x16x32_bf16 v[100:103], a[28:31], a[0:3], v[100:103]
    ds_read_b128 a[48:51], v10 offset:12288
    s_waitcnt lgkmcnt(3)
    v_mfma_f32_16x16x32_bf16 v[116:119], a[28:31], a[4:7], v[116:119]
    v_mfma_f32_16x16x32_bf16 v[112:115], a[24:27], a[4:7], v[112:115]
    ds_read_b128 a[52:55], v10 offset:13312
    v_mfma_f32_16x16x32_bf16 v[108:111], a[20:23], a[4:7], v[108:111]
    ds_read_b128 a[56:59], v10 offset:14336
    v_mfma_f32_16x16x32_bf16 v[104:107], a[16:19], a[4:7], v[104:107]
    ds_read_b128 a[60:63], v10 offset:15360
    v_mfma_f32_16x16x32_bf16 v[120:123], a[16:19], a[8:11], v[120:123]
    v_mfma_f32_16x16x32_bf16 v[124:127], a[20:23], a[8:11], v[124:127]
    ds_read_b64_tr_b16 a[36:37], v3 offset:12288
    v_mfma_f32_16x16x32_bf16 v[128:131], a[24:27], a[8:11], v[128:131]
    ds_read_b64_tr_b16 a[38:39], v3 offset:14336
    v_mfma_f32_16x16x32_bf16 v[132:135], a[28:31], a[8:11], v[132:135]
    ds_read_b64_tr_b16 a[40:41], v4 offset:12288
    v_mfma_f32_16x16x32_bf16 v[148:151], a[28:31], a[12:15], v[148:151]
    v_mfma_f32_16x16x32_bf16 v[144:147], a[24:27], a[12:15], v[144:147]
    ds_read_b64_tr_b16 a[42:43], v4 offset:14336
    v_mfma_f32_16x16x32_bf16 v[140:143], a[20:23], a[12:15], v[140:143]
    ds_read_b64_tr_b16 a[44:45], v5 offset:12288
    v_mfma_f32_16x16x32_bf16 v[136:139], a[16:19], a[12:15], v[136:139]
    ds_read_b64_tr_b16 a[46:47], v5 offset:14336
    s_waitcnt lgkmcnt(6)
    v_mfma_f32_16x16x32_bf16 v[88:91], a[48:51], a[32:35], v[88:91]
    s_barrier
    v_mfma_f32_16x16x32_bf16 v[92:95], a[52:55], a[32:35], v[92:95]
    v_mfma_f32_16x16x32_bf16 v[96:99], a[56:59], a[32:35], v[96:99]
    ds_read_b64_tr_b16 a[0:1], v2 offset:16384
    v_mfma_f32_16x16x32_bf16 v[100:103], a[60:63], a[32:35], v[100:103]
    ds_read_b64_tr_b16 a[2:3], v2 offset:18432
    s_waitcnt lgkmcnt(2)
    v_mfma_f32_16x16x32_bf16 v[116:119], a[60:63], a[36:39], v[116:119]
    ds_read_b128 a[16:19], v10 offset:16384
    v_mfma_f32_16x16x32_bf16 v[112:115], a[56:59], a[36:39], v[112:115]
    ds_read_b128 a[20:23], v10 offset:17408
    v_mfma_f32_16x16x32_bf16 v[108:111], a[52:55], a[36:39], v[108:111]
    v_mfma_f32_16x16x32_bf16 v[104:107], a[48:51], a[36:39], v[104:107]
    ds_read_b128 a[24:27], v10 offset:18432
    v_mfma_f32_16x16x32_bf16 v[120:123], a[48:51], a[40:43], v[120:123]
    ds_read_b128 a[28:31], v10 offset:19456
    v_mfma_f32_16x16x32_bf16 v[124:127], a[52:55], a[40:43], v[124:127]
    ds_read_b64_tr_b16 a[4:5], v3 offset:16384
    v_mfma_f32_16x16x32_bf16 v[128:131], a[56:59], a[40:43], v[128:131]
    ds_read_b64_tr_b16 a[6:7], v3 offset:18432
    v_mfma_f32_16x16x32_bf16 v[132:135], a[60:63], a[40:43], v[132:135]
    v_mfma_f32_16x16x32_bf16 v[148:151], a[60:63], a[44:47], v[148:151]
    ds_read_b64_tr_b16 a[8:9], v4 offset:16384
    v_mfma_f32_16x16x32_bf16 v[144:147], a[56:59], a[44:47], v[144:147]
    ds_read_b64_tr_b16 a[10:11], v4 offset:18432
    v_mfma_f32_16x16x32_bf16 v[140:143], a[52:55], a[44:47], v[140:143]
    ds_read_b64_tr_b16 a[12:13], v5 offset:16384
    v_mfma_f32_16x16x32_bf16 v[136:139], a[48:51], a[44:47], v[136:139]
    ds_read_b64_tr_b16 a[14:15], v5 offset:18432
    s_waitcnt lgkmcnt(6)
    v_mfma_f32_16x16x32_bf16 v[88:91], a[16:19], a[0:3], v[88:91]
    v_mfma_f32_16x16x32_bf16 v[92:95], a[20:23], a[0:3], v[92:95]
    ds_read_b64_tr_b16 a[32:33], v2 offset:20480
    v_mfma_f32_16x16x32_bf16 v[96:99], a[24:27], a[0:3], v[96:99]
    ds_read_b64_tr_b16 a[34:35], v2 offset:22528
    v_mfma_f32_16x16x32_bf16 v[100:103], a[28:31], a[0:3], v[100:103]
    ds_read_b128 a[48:51], v10 offset:20480
    s_waitcnt lgkmcnt(3)
    v_mfma_f32_16x16x32_bf16 v[116:119], a[28:31], a[4:7], v[116:119]
    v_mfma_f32_16x16x32_bf16 v[112:115], a[24:27], a[4:7], v[112:115]
    ds_read_b128 a[52:55], v10 offset:21504
    v_mfma_f32_16x16x32_bf16 v[108:111], a[20:23], a[4:7], v[108:111]
    ds_read_b128 a[56:59], v10 offset:22528
    v_mfma_f32_16x16x32_bf16 v[104:107], a[16:19], a[4:7], v[104:107]
    ds_read_b128 a[60:63], v10 offset:23552
    v_mfma_f32_16x16x32_bf16 v[120:123], a[16:19], a[8:11], v[120:123]
    v_mfma_f32_16x16x32_bf16 v[124:127], a[20:23], a[8:11], v[124:127]
    ds_read_b64_tr_b16 a[36:37], v3 offset:20480
    v_mfma_f32_16x16x32_bf16 v[128:131], a[24:27], a[8:11], v[128:131]
    ds_read_b64_tr_b16 a[38:39], v3 offset:22528
    v_mfma_f32_16x16x32_bf16 v[132:135], a[28:31], a[8:11], v[132:135]
    ds_read_b64_tr_b16 a[40:41], v4 offset:20480
    v_mfma_f32_16x16x32_bf16 v[148:151], a[28:31], a[12:15], v[148:151]
    v_mfma_f32_16x16x32_bf16 v[144:147], a[24:27], a[12:15], v[144:147]
    ds_read_b64_tr_b16 a[42:43], v4 offset:22528
    v_mfma_f32_16x16x32_bf16 v[140:143], a[20:23], a[12:15], v[140:143]
    ds_read_b64_tr_b16 a[44:45], v5 offset:20480
    v_mfma_f32_16x16x32_bf16 v[136:139], a[16:19], a[12:15], v[136:139]
    ds_read_b64_tr_b16 a[46:47], v5 offset:22528
    s_waitcnt lgkmcnt(6)
    v_mfma_f32_16x16x32_bf16 v[88:91], a[48:51], a[32:35], v[88:91]
    s_barrier
    v_mfma_f32_16x16x32_bf16 v[92:95], a[52:55], a[32:35], v[92:95]
    v_mfma_f32_16x16x32_bf16 v[96:99], a[56:59], a[32:35], v[96:99]
    ds_read_b64_tr_b16 a[0:1], v2 offset:24576
    v_mfma_f32_16x16x32_bf16 v[100:103], a[60:63], a[32:35], v[100:103]
    ds_read_b64_tr_b16 a[2:3], v2 offset:26624
    s_waitcnt lgkmcnt(2)
    v_mfma_f32_16x16x32_bf16 v[116:119], a[60:63], a[36:39], v[116:119]
    ds_read_b128 a[16:19], v10 offset:24576
    v_mfma_f32_16x16x32_bf16 v[112:115], a[56:59], a[36:39], v[112:115]
    ds_read_b128 a[20:23], v10 offset:25600
    v_mfma_f32_16x16x32_bf16 v[108:111], a[52:55], a[36:39], v[108:111]
    v_mfma_f32_16x16x32_bf16 v[104:107], a[48:51], a[36:39], v[104:107]
    ds_read_b128 a[24:27], v10 offset:26624
    v_mfma_f32_16x16x32_bf16 v[120:123], a[48:51], a[40:43], v[120:123]
    ds_read_b128 a[28:31], v10 offset:27648
    v_mfma_f32_16x16x32_bf16 v[124:127], a[52:55], a[40:43], v[124:127]
    ds_read_b64_tr_b16 a[4:5], v3 offset:24576
    v_mfma_f32_16x16x32_bf16 v[128:131], a[56:59], a[40:43], v[128:131]
    ds_read_b64_tr_b16 a[6:7], v3 offset:26624
    v_mfma_f32_16x16x32_bf16 v[132:135], a[60:63], a[40:43], v[132:135]
    v_mfma_f32_16x16x32_bf16 v[148:151], a[60:63], a[44:47], v[148:151]
    ds_read_b64_tr_b16 a[8:9], v4 offset:24576
    v_mfma_f32_16x16x32_bf16 v[144:147], a[56:59], a[44:47], v[144:147]
    ds_read_b64_tr_b16 a[10:11], v4 offset:26624
    v_mfma_f32_16x16x32_bf16 v[140:143], a[52:55], a[44:47], v[140:143]
    ds_read_b64_tr_b16 a[12:13], v5 offset:24576
    v_mfma_f32_16x16x32_bf16 v[136:139], a[48:51], a[44:47], v[136:139]
    ds_read_b64_tr_b16 a[14:15], v5 offset:26624
    s_waitcnt lgkmcnt(6)
    v_mfma_f32_16x16x32_bf16 v[88:91], a[16:19], a[0:3], v[88:91]
    v_mfma_f32_16x16x32_bf16 v[92:95], a[20:23], a[0:3], v[92:95]
    ds_read_b64_tr_b16 a[32:33], v2 offset:28672
    v_mfma_f32_16x16x32_bf16 v[96:99], a[24:27], a[0:3], v[96:99]
    ds_read_b64_tr_b16 a[34:35], v2 offset:30720
    v_mfma_f32_16x16x32_bf16 v[100:103], a[28:31], a[0:3], v[100:103]
    ds_read_b128 a[48:51], v10 offset:28672
    s_waitcnt lgkmcnt(3)
    v_mfma_f32_16x16x32_bf16 v[116:119], a[28:31], a[4:7], v[116:119]
    v_mfma_f32_16x16x32_bf16 v[112:115], a[24:27], a[4:7], v[112:115]
    ds_read_b128 a[52:55], v10 offset:29696
    v_mfma_f32_16x16x32_bf16 v[108:111], a[20:23], a[4:7], v[108:111]
    ds_read_b128 a[56:59], v10 offset:30720
    v_mfma_f32_16x16x32_bf16 v[104:107], a[16:19], a[4:7], v[104:107]
    ds_read_b128 a[60:63], v10 offset:31744
    v_mfma_f32_16x16x32_bf16 v[120:123], a[16:19], a[8:11], v[120:123]
    v_mfma_f32_16x16x32_bf16 v[124:127], a[20:23], a[8:11], v[124:127]
    ds_read_b64_tr_b16 a[36:37], v3 offset:28672
    v_mfma_f32_16x16x32_bf16 v[128:131], a[24:27], a[8:11], v[128:131]
    ds_read_b64_tr_b16 a[38:39], v3 offset:30720
    v_mfma_f32_16x16x32_bf16 v[132:135], a[28:31], a[8:11], v[132:135]
    ds_read_b64_tr_b16 a[40:41], v4 offset:28672
    v_mfma_f32_16x16x32_bf16 v[148:151], a[28:31], a[12:15], v[148:151]
    v_mfma_f32_16x16x32_bf16 v[144:147], a[24:27], a[12:15], v[144:147]
    ds_read_b64_tr_b16 a[42:43], v4 offset:30720
    v_mfma_f32_16x16x32_bf16 v[140:143], a[20:23], a[12:15], v[140:143]
    ds_read_b64_tr_b16 a[44:45], v5 offset:28672
    v_mfma_f32_16x16x32_bf16 v[136:139], a[16:19], a[12:15], v[136:139]
    ds_read_b64_tr_b16 a[46:47], v5 offset:30720
    s_waitcnt lgkmcnt(6)
    v_mfma_f32_16x16x32_bf16 v[88:91], a[48:51], a[32:35], v[88:91]
    s_barrier
    v_mfma_f32_16x16x32_bf16 v[92:95], a[52:55], a[32:35], v[92:95]
    v_mfma_f32_16x16x32_bf16 v[96:99], a[56:59], a[32:35], v[96:99]
    ds_read_b64_tr_b16 a[0:1], v2 offset:32768
    v_mfma_f32_16x16x32_bf16 v[100:103], a[60:63], a[32:35], v[100:103]
    ds_read_b64_tr_b16 a[2:3], v2 offset:34816
    s_waitcnt lgkmcnt(2)
    v_mfma_f32_16x16x32_bf16 v[116:119], a[60:63], a[36:39], v[116:119]
    ds_read_b128 v[24:27], v10 offset:32768
    v_mfma_f32_16x16x32_bf16 v[112:115], a[56:59], a[36:39], v[112:115]
    ds_read_b128 v[28:31], v10 offset:33792
    v_mfma_f32_16x16x32_bf16 v[108:111], a[52:55], a[36:39], v[108:111]
    v_mfma_f32_16x16x32_bf16 v[104:107], a[48:51], a[36:39], v[104:107]
    ds_read_b128 v[32:35], v10 offset:34816
    v_mfma_f32_16x16x32_bf16 v[120:123], a[48:51], a[40:43], v[120:123]
    ds_read_b128 v[36:39], v10 offset:35840
    v_mfma_f32_16x16x32_bf16 v[124:127], a[52:55], a[40:43], v[124:127]
    ds_read_b64_tr_b16 a[4:5], v2 offset:36864
    v_mfma_f32_16x16x32_bf16 v[128:131], a[56:59], a[40:43], v[128:131]
    ds_read_b64_tr_b16 a[6:7], v2 offset:38912
    v_mfma_f32_16x16x32_bf16 v[132:135], a[60:63], a[40:43], v[132:135]
    v_mfma_f32_16x16x32_bf16 v[148:151], a[60:63], a[44:47], v[148:151]
    ds_read_b128 v[40:43], v10 offset:36864
    v_mfma_f32_16x16x32_bf16 v[144:147], a[56:59], a[44:47], v[144:147]
    ds_read_b128 v[44:47], v10 offset:37888
    v_mfma_f32_16x16x32_bf16 v[140:143], a[52:55], a[44:47], v[140:143]
    ds_read_b128 v[48:51], v10 offset:38912
    v_mfma_f32_16x16x32_bf16 v[136:139], a[48:51], a[44:47], v[136:139]
    ds_read_b128 v[52:55], v10 offset:39936
    s_waitcnt lgkmcnt(6)
    v_mfma_f32_16x16x32_bf16 v[88:91], v[24:27], a[0:3], v[88:91]
    s_barrier
    v_mfma_f32_16x16x32_bf16 v[92:95], v[28:31], a[0:3], v[92:95]
    ds_read_b64_tr_b16 a[8:9], v2 offset:0
    v_mfma_f32_16x16x32_bf16 v[96:99], v[32:35], a[0:3], v[96:99]
    ds_read_b64_tr_b16 a[10:11], v2 offset:2048
    ds_read_b128 v[56:59], v10 offset:0
    v_mfma_f32_16x16x32_bf16 v[100:103], v[36:39], a[0:3], v[100:103]
    ds_read_b128 v[60:63], v10 offset:1024
    s_waitcnt lgkmcnt(4)
    v_mfma_f32_16x16x32_bf16 v[88:91], v[40:43], a[4:7], v[88:91]
    ds_read_b128 v[64:67], v10 offset:2048
    ds_read_b128 v[68:71], v10 offset:3072
    v_mfma_f32_16x16x32_bf16 v[92:95], v[44:47], a[4:7], v[92:95]
    ds_read_b64_tr_b16 a[12:13], v2 offset:4096
    v_mfma_f32_16x16x32_bf16 v[96:99], v[48:51], a[4:7], v[96:99]
    ds_read_b64_tr_b16 a[14:15], v2 offset:6144
    ds_read_b128 v[72:75], v10 offset:4096
    v_mfma_f32_16x16x32_bf16 v[100:103], v[52:55], a[4:7], v[100:103]
    ds_read_b128 v[76:79], v10 offset:5120
    s_waitcnt lgkmcnt(4)
    v_mfma_f32_16x16x32_bf16 v[88:91], v[56:59], a[8:11], v[88:91]
    ds_read_b128 v[80:83], v10 offset:6144
    ds_read_b128 v[84:87], v10 offset:7168
    v_mfma_f32_16x16x32_bf16 v[92:95], v[60:63], a[8:11], v[92:95]
    ds_read_b64_tr_b16 a[16:17], v3 offset:32768
    v_mfma_f32_16x16x32_bf16 v[96:99], v[64:67], a[8:11], v[96:99]
    ds_read_b64_tr_b16 a[18:19], v3 offset:34816
    ds_read_b64_tr_b16 a[20:21], v3 offset:36864
    v_mfma_f32_16x16x32_bf16 v[100:103], v[68:71], a[8:11], v[100:103]
    ds_read_b64_tr_b16 a[22:23], v3 offset:38912
    s_waitcnt lgkmcnt(4)
    v_mfma_f32_16x16x32_bf16 v[88:91], v[72:75], a[12:15], v[88:91]
    ds_read_b64_tr_b16 a[24:25], v3 offset:0
    ds_read_b64_tr_b16 a[26:27], v3 offset:2048
    v_mfma_f32_16x16x32_bf16 v[92:95], v[76:79], a[12:15], v[92:95]
    ds_read_b64_tr_b16 a[28:29], v3 offset:4096
    ds_read_b64_tr_b16 a[30:31], v3 offset:6144
    v_mfma_f32_16x16x32_bf16 v[96:99], v[80:83], a[12:15], v[96:99]
    v_mfma_f32_16x16x32_bf16 v[100:103], v[84:87], a[12:15], v[100:103]
    s_waitcnt lgkmcnt(4)
    v_mfma_f32_16x16x32_bf16 v[104:107], v[24:27], a[16:19], v[104:107]
    v_mfma_f32_16x16x32_bf16 v[108:111], v[28:31], a[16:19], v[108:111]
    ds_read_b64_tr_b16 a[0:1], v4 offset:32768
    v_mfma_f32_16x16x32_bf16 v[112:115], v[32:35], a[16:19], v[112:115]
    v_cvt_pk_bf16_f32 v88, v88, v89
    v_cvt_pk_bf16_f32 v89, v90, v91
    ds_write_b64 v12, v[88:89] offset:0
    v_cvt_pk_bf16_f32 v92, v92, v93
    v_mfma_f32_16x16x32_bf16 v[116:119], v[36:39], a[16:19], v[116:119]
    ds_read_b64_tr_b16 a[2:3], v4 offset:34816
    v_cvt_pk_bf16_f32 v93, v94, v95
    ds_write_b64 v21, v[92:93] offset:0
    v_cvt_pk_bf16_f32 v96, v96, v97
    v_mfma_f32_16x16x32_bf16 v[104:107], v[40:43], a[20:23], v[104:107]
    v_cvt_pk_bf16_f32 v97, v98, v99
    ds_write_b64 v22, v[96:97] offset:0
    v_cvt_pk_bf16_f32 v100, v100, v101
    v_cvt_pk_bf16_f32 v101, v102, v103
    v_mfma_f32_16x16x32_bf16 v[108:111], v[44:47], a[20:23], v[108:111]
    ds_read_b64_tr_b16 a[4:5], v4 offset:36864
    ds_write_b64 v23, v[100:101] offset:0
    ds_read_b128 v[168:171], v13 offset:0
    ds_read_b128 v[172:175], v13 offset:1024
    v_mfma_f32_16x16x32_bf16 v[112:115], v[48:51], a[20:23], v[112:115]
    v_mfma_f32_16x16x32_bf16 v[116:119], v[52:55], a[20:23], v[116:119]
    ds_read_b64_tr_b16 a[6:7], v4 offset:38912
    s_waitcnt lgkmcnt(10)
    v_mfma_f32_16x16x32_bf16 v[104:107], v[56:59], a[24:27], v[104:107]
    s_waitcnt lgkmcnt(2)
    buffer_store_dwordx4 v[168:171], v14, s[20:23], s59 offen sc1 nt
    s_add_u32 s59, s59, 65536
    v_mfma_f32_16x16x32_bf16 v[108:111], v[60:63], a[24:27], v[108:111]
    ds_read_b64_tr_b16 a[8:9], v4 offset:0
    v_mfma_f32_16x16x32_bf16 v[112:115], v[64:67], a[24:27], v[112:115]
    s_waitcnt lgkmcnt(2)
    buffer_store_dwordx4 v[172:175], v14, s[20:23], s59 offen sc1 nt
    s_add_u32 s59, s59, 65536
    v_mfma_f32_16x16x32_bf16 v[116:119], v[68:71], a[24:27], v[116:119]
    ds_read_b64_tr_b16 a[10:11], v4 offset:2048
    v_mfma_f32_16x16x32_bf16 v[104:107], v[72:75], a[28:31], v[104:107]
    v_mfma_f32_16x16x32_bf16 v[108:111], v[76:79], a[28:31], v[108:111]
    ds_read_b64_tr_b16 a[12:13], v4 offset:4096
    v_mfma_f32_16x16x32_bf16 v[112:115], v[80:83], a[28:31], v[112:115]
    v_mfma_f32_16x16x32_bf16 v[116:119], v[84:87], a[28:31], v[116:119]
    ds_read_b64_tr_b16 a[14:15], v4 offset:6144
    s_waitcnt lgkmcnt(4)
    v_mfma_f32_16x16x32_bf16 v[120:123], v[24:27], a[0:3], v[120:123]
    v_mfma_f32_16x16x32_bf16 v[124:127], v[28:31], a[0:3], v[124:127]
    ds_read_b64_tr_b16 a[16:17], v5 offset:32768
    v_mfma_f32_16x16x32_bf16 v[128:131], v[32:35], a[0:3], v[128:131]
    v_cvt_pk_bf16_f32 v104, v104, v105
    v_cvt_pk_bf16_f32 v105, v106, v107
    v_mfma_f32_16x16x32_bf16 v[132:135], v[36:39], a[0:3], v[132:135]
    ds_read_b64_tr_b16 a[18:19], v5 offset:34816
    ds_write_b64 v12, v[104:105] offset:2048
    v_cvt_pk_bf16_f32 v108, v108, v109
    v_mfma_f32_16x16x32_bf16 v[120:123], v[40:43], a[4:7], v[120:123]
    v_cvt_pk_bf16_f32 v109, v110, v111
    v_mfma_f32_16x16x32_bf16 v[124:127], v[44:47], a[4:7], v[124:127]
    ds_read_b64_tr_b16 a[20:21], v5 offset:36864
    ds_write_b64 v21, v[108:109] offset:2048
    v_cvt_pk_bf16_f32 v112, v112, v113
    v_mfma_f32_16x16x32_bf16 v[128:131], v[48:51], a[4:7], v[128:131]
    v_cvt_pk_bf16_f32 v113, v114, v115
    v_mfma_f32_16x16x32_bf16 v[132:135], v[52:55], a[4:7], v[132:135]
    ds_read_b64_tr_b16 a[22:23], v5 offset:38912
    ds_write_b64 v22, v[112:113] offset:2048
    v_cvt_pk_bf16_f32 v116, v116, v117
    s_waitcnt lgkmcnt(7)
    v_mfma_f32_16x16x32_bf16 v[120:123], v[56:59], a[8:11], v[120:123]
    v_cvt_pk_bf16_f32 v117, v118, v119
    v_mfma_f32_16x16x32_bf16 v[124:127], v[60:63], a[8:11], v[124:127]
    ds_read_b64_tr_b16 a[24:25], v5 offset:0
    ds_write_b64 v23, v[116:117] offset:2048
    ds_read_b128 v[176:179], v13 offset:2048
    v_mfma_f32_16x16x32_bf16 v[128:131], v[64:67], a[8:11], v[128:131]
    ds_read_b128 v[180:183], v13 offset:3072
    v_mfma_f32_16x16x32_bf16 v[132:135], v[68:71], a[8:11], v[132:135]
    ds_read_b64_tr_b16 a[26:27], v5 offset:2048
    v_mfma_f32_16x16x32_bf16 v[120:123], v[72:75], a[12:15], v[120:123]
    v_mfma_f32_16x16x32_bf16 v[124:127], v[76:79], a[12:15], v[124:127]
    ds_read_b64_tr_b16 a[28:29], v5 offset:4096
    s_waitcnt lgkmcnt(3)
    buffer_store_dwordx4 v[176:179], v14, s[20:23], s59 offen sc1 nt
    s_add_u32 s59, s59, 65536
    v_mfma_f32_16x16x32_bf16 v[128:131], v[80:83], a[12:15], v[128:131]
    v_mfma_f32_16x16x32_bf16 v[132:135], v[84:87], a[12:15], v[132:135]
    ds_read_b64_tr_b16 a[30:31], v5 offset:6144
    s_waitcnt lgkmcnt(3)
    buffer_store_dwordx4 v[180:183], v14, s[20:23], s59 offen sc1 nt
    s_add_u32 s59, s59, 65536
    v_mfma_f32_16x16x32_bf16 v[136:139], v[24:27], a[16:19], v[136:139]
    v_mfma_f32_16x16x32_bf16 v[140:143], v[28:31], a[16:19], v[140:143]
    v_mfma_f32_16x16x32_bf16 v[144:147], v[32:35], a[16:19], v[144:147]
    v_cvt_pk_bf16_f32 v120, v120, v121
    v_cvt_pk_bf16_f32 v121, v122, v123
    v_mfma_f32_16x16x32_bf16 v[148:151], v[36:39], a[16:19], v[148:151]
    ds_write_b64 v12, v[120:121] offset:4096
    v_cvt_pk_bf16_f32 v124, v124, v125
    v_mfma_f32_16x16x32_bf16 v[136:139], v[40:43], a[20:23], v[136:139]
    v_cvt_pk_bf16_f32 v125, v126, v127
    v_mfma_f32_16x16x32_bf16 v[140:143], v[44:47], a[20:23], v[140:143]
    ds_write_b64 v21, v[124:125] offset:4096
    v_cvt_pk_bf16_f32 v128, v128, v129
    v_mfma_f32_16x16x32_bf16 v[144:147], v[48:51], a[20:23], v[144:147]
    v_cvt_pk_bf16_f32 v129, v130, v131
    v_mfma_f32_16x16x32_bf16 v[148:151], v[52:55], a[20:23], v[148:151]
    ds_write_b64 v22, v[128:129] offset:4096
    v_cvt_pk_bf16_f32 v132, v132, v133
    s_waitcnt lgkmcnt(3)
    v_mfma_f32_16x16x32_bf16 v[136:139], v[56:59], a[24:27], v[136:139]
    v_cvt_pk_bf16_f32 v133, v134, v135
    v_mfma_f32_16x16x32_bf16 v[140:143], v[60:63], a[24:27], v[140:143]
    ds_write_b64 v23, v[132:133] offset:4096
    ds_read_b128 v[184:187], v13 offset:4096
    v_mfma_f32_16x16x32_bf16 v[144:147], v[64:67], a[24:27], v[144:147]
    ds_read_b128 v[188:191], v13 offset:5120
    v_mfma_f32_16x16x32_bf16 v[148:151], v[68:71], a[24:27], v[148:151]
    v_mfma_f32_16x16x32_bf16 v[136:139], v[72:75], a[28:31], v[136:139]
    v_mfma_f32_16x16x32_bf16 v[140:143], v[76:79], a[28:31], v[140:143]
    s_waitcnt lgkmcnt(1)
    buffer_store_dwordx4 v[184:187], v14, s[20:23], s59 offen sc1 nt
    s_add_u32 s59, s59, 65536
    v_mfma_f32_16x16x32_bf16 v[144:147], v[80:83], a[28:31], v[144:147]
    v_mfma_f32_16x16x32_bf16 v[148:151], v[84:87], a[28:31], v[148:151]
    s_waitcnt lgkmcnt(0)
    buffer_store_dwordx4 v[188:191], v14, s[20:23], s59 offen sc1 nt
    s_add_u32 s59, s59, 65536
    s_nop 1
    v_cvt_pk_bf16_f32 v136, v136, v137
    v_cvt_pk_bf16_f32 v137, v138, v139
    ds_write_b64 v12, v[136:137] offset:6144
    v_cvt_pk_bf16_f32 v140, v140, v141
    v_cvt_pk_bf16_f32 v141, v142, v143
    ds_write_b64 v21, v[140:141] offset:6144
    v_cvt_pk_bf16_f32 v144, v144, v145
    v_cvt_pk_bf16_f32 v145, v146, v147
    ds_write_b64 v22, v[144:145] offset:6144
    v_cvt_pk_bf16_f32 v148, v148, v149
    v_cvt_pk_bf16_f32 v149, v150, v151
    ds_write_b64 v23, v[148:149] offset:6144
    ds_read_b128 v[168:171], v13 offset:6144
    ds_read_b128 v[172:175], v13 offset:7168
    s_waitcnt lgkmcnt(1)
    buffer_store_dwordx4 v[168:171], v14, s[20:23], s59 offen sc1 nt
    s_add_u32 s59, s59, 65536
    s_waitcnt lgkmcnt(0)
    buffer_store_dwordx4 v[172:175], v14, s[20:23], s59 offen sc1 nt
Lend:
    s_endpgm
.fill 64, 4, 0xbf800000
.section .rodata,"a"
.p2align 6
.amdhsa_kernel standalone__edm_precond__diffusion_kernel
  .amdhsa_next_free_vgpr 256
  .amdhsa_next_free_sgpr 102
  .amdhsa_accum_offset 192
  .amdhsa_group_segment_fixed_size 0
  .amdhsa_kernarg_size 64
  .amdhsa_user_sgpr_count 2
  .amdhsa_user_sgpr_kernarg_segment_ptr 1
  .amdhsa_system_sgpr_workgroup_id_x 1
.end_amdhsa_kernel
```
